```python
import torch

def _softmax(x, axis=-1):
    return torch.softmax(x, dim=axis)
def _gelu(x):
    return torch.nn.functional.gelu(x, approximate="tanh")
def _silu(x):
    return torch.nn.functional.silu(x)
def _sigmoid(x):
    return torch.sigmoid(x)
def _layernorm(x, axis=-1, eps=1e-5):
    m = x.mean(dim=axis, keepdim=True)
    v = x.var(dim=axis, keepdim=True, unbiased=False)
    return (x - m) / torch.sqrt(v + eps)
def _scatter_add(tgt, idx, src, axis=0):
    return tgt.clone().index_add_(axis, idx, src)
def _segment_sum(src, seg, n):
    out = torch.zeros((n,) + src.shape[1:], dtype=src.dtype)
    return out.index_add_(0, seg, src)
def _pad(x, pw):
    flat = tuple(v for pair in reversed(pw) for v in pair)
    return torch.nn.functional.pad(x, flat)

kernel_name = 'sequential_preLN__sliding_block_cached__glu_gated_swiglu__decode'

def setup_inputs():

    _w = (lambda a: (lambda t: t.to(torch.bfloat16) if t.is_floating_point() else t)(torch.as_tensor(a)))
    def _A_setup():
        B, Sq, D = 1, 1, 512
        Hq, Hkv, Sk, Dh = 32, 8, 32768, 128
        assert Hq % Hkv == 0, (Hq, Hkv)
        return {
            "x": _w((lambda *s: torch.randn(*s, dtype=torch.bfloat16) * 0.05)(B, Sq, D)),
            "k_cache": _w((lambda *s: torch.randn(*s, dtype=torch.bfloat16) * 1.6)(B, Hkv, Sk, Dh)),
            "v_cache": _w((lambda *s: torch.randn(*s, dtype=torch.bfloat16) * 0.8)(B, Hkv, Sk, Dh)),
            "wq": _w((lambda *s: torch.randn(*s, dtype=torch.bfloat16) * 1.6)(D, Hq * Dh) * (D ** -0.5)),
            "wo": _w((lambda *s: torch.randn(*s, dtype=torch.bfloat16) * 0.8)(Hq * Dh, D) * ((Hq * Dh) ** -0.5)),
        }
    _A_in = _A_setup()

    def _B_setup():
        B, S, D, F = 1, 1, 512, 1792
        return {
            "x": _w((lambda *s: torch.randn(*s, dtype=torch.bfloat16) * 0.05)(B, S, D)),
            "w1": _w((lambda *s: torch.randn(*s, dtype=torch.bfloat16) * 0.4)(D, F) * (2.0 / D) ** 0.5),
            "w3": _w((lambda *s: torch.randn(*s, dtype=torch.bfloat16) * 0.4)(D, F) * (2.0 / D) ** 0.5),
            "w2": _w((lambda *s: torch.randn(*s, dtype=torch.bfloat16) * 0.4)(F, D) * (2.0 / F) ** 0.5),
        }
    _B_in = _B_setup()

    return {
        "A_x": _A_in["x"],
        "A_k_cache": _A_in["k_cache"],
        "A_v_cache": _A_in["v_cache"],
        "A_wq": _A_in["wq"],
        "A_wo": _A_in["wo"],
        "B_x": _B_in["x"],
        "B_w1": _B_in["w1"],
        "B_w3": _B_in["w3"],
        "B_w2": _B_in["w2"],
    }

def reference(A_x, A_k_cache, A_v_cache, A_wq, A_wo, B_x, B_w1, B_w3, B_w2):
    def _A_ref(x, k_cache, v_cache, wq, wo):
        B, Sq, D = x.shape
        Hq, Dh = 32, 128
        Hkv, Sk = k_cache.shape[1], k_cache.shape[2]
        W = min(4096, max(256, Sk // 4))
        rep = Hq // Hkv
        q = (lambda x, *d: x.permute(*d))((x @ wq).reshape(B, Sq, Hq, Dh), 0, 2, 1, 3)
        k = (lambda x, n, axis: torch.repeat_interleave(x, n, dim=axis))(k_cache[:, :, Sk - W:, :], rep, axis=1)
        v = (lambda x, n, axis: torch.repeat_interleave(x, n, dim=axis))(v_cache[:, :, Sk - W:, :], rep, axis=1)
        scores = torch.einsum("bhqd,bhkd->bhqk", q, k) * (Dh ** -0.5)
        p = _softmax(scores, axis=-1)
        o = torch.einsum("bhqk,bhkd->bhqd", p, v)
        return (lambda x, *d: x.permute(*d))(o, 0, 2, 1, 3).reshape(B, Sq, Hq * Dh) @ wo

    def _B_ref(x, w1, w3, w2):
        gate = torch.einsum("bsd,df->bsf", x, w1)
        up = torch.einsum("bsd,df->bsf", x, w3)
        h = _silu(gate) * up
        out = torch.einsum("bsf,fd->bsd", h, w2)
        return out

    x = A_x
    h = x + _A_ref(_layernorm(x, axis=-1), A_k_cache, A_v_cache, A_wq, A_wo)
    h2 = h + _B_ref(_layernorm(h, axis=-1), B_w1, B_w3, B_w2)
    return h2
```

```asm
; @launch grid=(256,1,1) block=(320,1,1) lds=14656
.amdgcn_target "amdgcn-amd-amdhsa--gfx950"
.text
.globl sequential_preLN__sliding_block_cached__glu_gated_swiglu__decode_kernel
.p2align 8
.type sequential_preLN__sliding_block_cached__glu_gated_swiglu__decode_kernel,@function
sequential_preLN__sliding_block_cached__glu_gated_swiglu__decode_kernel:
    s_load_dwordx2 s[40:41], s[0:1], 0
    s_load_dwordx2 s[16:17], s[0:1], 24
    s_load_dwordx4 s[8:11], s[0:1], 8
    s_load_dwordx2 s[36:37], s[0:1], 88
    v_readfirstlane_b32 s3, v0
    s_cmpk_ge_u32 s2, 256
    s_cbranch_scc1 L_end
    s_lshr_b32 s3, s3, 6
    s_cbranch_scc0 L_q
    s_cmp_lg_u32 s3, 4
    s_cbranch_scc1 L_kreg
    s_cmp_ge_u32 s2, 16
    s_cbranch_scc1 L_100
    s_getpc_b64 s[64:65]
L_pc:
    v_lshlrev_b32 v7, 7, v0
    v_add_u32 v7, 0xffff8000, v7
    global_load_dword v140, v7, s[64:65]
    v_add_u32 v7, 0x2000, v7
    v_min_u32 v7, L_end-L_pc, v7
    global_load_dword v140, v7, s[64:65]
    s_branch L_100
L_q:
    s_mov_b32 s43, 0x20000
    s_movk_i32 s42, 1024
    s_mov_b32 s19, s43
    s_lshl_b32 s18, 1, 22
    s_bfe_u32 s66, s2, 0x20003
    s_lshr_b32 s67, s2, 5
    s_and_b32 s48, s2, 7
    v_lshlrev_b32 v4, 4, v0
    v_lshrrev_b32 v5, 3, v0
    v_lshlrev_b32 v6, 17, v5
    v_and_b32 v7, 7, v0
    v_lshl_add_u32 v6, v7, 4, v6
    v_lshlrev_b32 v5, 5, v5
    s_lshl_b32 s62, s66, 8
    s_lshl_b32 s63, s66, 10
    s_add_u32 s63, s63, s48
    s_lshl3_add_u32 s63, s63, s67
    s_lshl_b32 s63, s63, 7
    s_waitcnt lgkmcnt(0)
    buffer_load_dwordx4 v[16:19], v4, s[40:43], 0 offen
    buffer_load_dwordx4 v[20:23], v5, s[40:43], s62 offen
    buffer_load_dwordx4 v[24:27], v5, s[40:43], s62 offen offset:16
    buffer_load_dwordx4 v[64:67], v6, s[16:19], s63 offen nt
    s_branch L_q2
.p2align 8
L_100:
    s_branch L_kreg
L_q2:
    s_setprio 3
    s_movk_i32 s65, 0x2000
    s_add_u32 s63, s63, s65
    buffer_load_dwordx4 v[68:71], v6, s[16:19], s63 offen nt
    s_add_u32 s63, s63, s65
    buffer_load_dwordx4 v[72:75], v6, s[16:19], s63 offen nt
    s_add_u32 s63, s63, s65
    buffer_load_dwordx4 v[76:79], v6, s[16:19], s63 offen nt
    s_add_u32 s63, s63, s65
    buffer_load_dwordx4 v[80:83], v6, s[16:19], s63 offen nt
    s_add_u32 s63, s63, s65
    buffer_load_dwordx4 v[84:87], v6, s[16:19], s63 offen nt
    s_add_u32 s63, s63, s65
    buffer_load_dwordx4 v[88:91], v6, s[16:19], s63 offen nt
    s_add_u32 s63, s63, s65
    buffer_load_dwordx4 v[92:95], v6, s[16:19], s63 offen nt
    s_add_u32 s63, s63, s65
    buffer_load_dwordx4 v[96:99], v6, s[16:19], s63 offen nt
    s_add_u32 s63, s63, s65
    buffer_load_dwordx4 v[100:103], v6, s[16:19], s63 offen nt
    s_add_u32 s63, s63, s65
    buffer_load_dwordx4 v[104:107], v6, s[16:19], s63 offen nt
    s_add_u32 s63, s63, s65
    buffer_load_dwordx4 v[108:111], v6, s[16:19], s63 offen nt
    s_add_u32 s63, s63, s65
    buffer_load_dwordx4 v[112:115], v6, s[16:19], s63 offen nt
    s_add_u32 s63, s63, s65
    buffer_load_dwordx4 v[116:119], v6, s[16:19], s63 offen nt
    s_add_u32 s63, s63, s65
    buffer_load_dwordx4 v[120:123], v6, s[16:19], s63 offen nt
    s_add_u32 s63, s63, s65
    buffer_load_dwordx4 v[124:127], v6, s[16:19], s63 offen nt
    s_load_dword s52, s[36:37], 0
    s_mov_b32 s39, s43
    s_lshl_b32 s38, 1, 28
    s_lshr_b32 s49, s2, 3
    v_and_b32 v2, 15, v0
    v_lshrrev_b32 v3, 4, v0
    s_mov_b32 s58, 0xff
    s_mov_b32 s59, 0xffff0000
    s_mov_b32 s57, 0
    s_mov_b32 s56, 0
    v_and_b32 v7, 1, v2
    v_lshlrev_b32 v7, 4, v7
    v_mov_b32 v13, 0xffff
    v_lshlrev_b32 v13, v7, v13
    v_bfe_u32 v7, v2, 1, 2
    v_cmp_eq_u32 vcc, 0, v7
    s_nop 1
    v_cndmask_b32 v8, 0, v13, vcc
    v_cmp_eq_u32 vcc, 1, v7
    s_nop 1
    v_cndmask_b32 v9, 0, v13, vcc
    v_cmp_eq_u32 vcc, 2, v7
    s_nop 1
    v_cndmask_b32 v10, 0, v13, vcc
    v_cmp_eq_u32 vcc, 3, v7
    s_nop 1
    v_cndmask_b32 v11, 0, v13, vcc
    s_getreg_b32 s68, hwreg(HW_REG_XCC_ID)
    s_and_b32 s68, s68, 0xff
    v_and_b32 v7, 7, v0
    v_lshl_add_u32 v7, v3, 3, v7
    v_lshlrev_b32 v7, 4, v7
    s_lshl_b32 s62, s48, 13
    s_add_u32 s62, s62, 4096
    s_lshl_b32 s63, s66, 11
    s_add_u32 s63, s63, s62
    s_lshl_b32 s64, s67, 8
    s_add_u32 s63, s63, s64
    s_add_u32 s64, s62, 4096
    v_mov_b32 v13, s68
    s_waitcnt vmcnt(18)
    v_lshlrev_b32 v28, 16, v16
    v_and_b32 v29, s59, v16
    v_lshlrev_b32 v30, 16, v17
    v_and_b32 v31, s59, v17
    v_lshlrev_b32 v32, 16, v18
    v_and_b32 v33, s59, v18
    v_lshlrev_b32 v34, 16, v19
    v_and_b32 v35, s59, v19
    v_pk_add_f32 v[36:37], v[28:29], v[30:31]
    v_pk_add_f32 v[38:39], v[32:33], v[34:35]
    v_pk_add_f32 v[36:37], v[36:37], v[38:39]
    v_add_f32 v36, v36, v37
    s_nop 1
    v_add_f32_dpp v36, v36, v36 row_ror:8 row_mask:0xf bank_mask:0xf
    s_nop 1
    v_add_f32_dpp v36, v36, v36 row_ror:4 row_mask:0xf bank_mask:0xf
    s_nop 1
    v_add_f32_dpp v36, v36, v36 row_ror:2 row_mask:0xf bank_mask:0xf
    s_nop 1
    v_add_f32_dpp v36, v36, v36 row_ror:1 row_mask:0xf bank_mask:0xf
    s_nop 1
    v_add_f32_dpp v36, v36, v36 row_bcast:15 row_mask:0xa bank_mask:0xf
    s_nop 1
    v_add_f32_dpp v36, v36, v36 row_bcast:31 row_mask:0xc bank_mask:0xf
    s_nop 0
    v_readlane_b32 s53, v36, 63
    v_mov_b32 v14, 0x3b000000
    s_nop 0
    v_mul_f32 v14, s53, v14
    v_pk_add_f32 v[28:29], v[28:29], v[14:15] op_sel_hi:[1,0] neg_lo:[0,1] neg_hi:[0,1]
    v_pk_add_f32 v[30:31], v[30:31], v[14:15] op_sel_hi:[1,0] neg_lo:[0,1] neg_hi:[0,1]
    v_pk_add_f32 v[32:33], v[32:33], v[14:15] op_sel_hi:[1,0] neg_lo:[0,1] neg_hi:[0,1]
    v_pk_add_f32 v[34:35], v[34:35], v[14:15] op_sel_hi:[1,0] neg_lo:[0,1] neg_hi:[0,1]
    v_pk_mul_f32 v[36:37], v[28:29], v[28:29]
    v_pk_fma_f32 v[36:37], v[30:31], v[30:31], v[36:37]
    v_pk_fma_f32 v[36:37], v[32:33], v[32:33], v[36:37]
    v_pk_fma_f32 v[36:37], v[34:35], v[34:35], v[36:37]
    v_add_f32 v36, v36, v37
    s_nop 1
    v_add_f32_dpp v36, v36, v36 row_ror:8 row_mask:0xf bank_mask:0xf
    s_nop 1
    v_add_f32_dpp v36, v36, v36 row_ror:4 row_mask:0xf bank_mask:0xf
    s_nop 1
    v_add_f32_dpp v36, v36, v36 row_ror:2 row_mask:0xf bank_mask:0xf
    s_nop 1
    v_add_f32_dpp v36, v36, v36 row_ror:1 row_mask:0xf bank_mask:0xf
    s_nop 1
    v_add_f32_dpp v36, v36, v36 row_bcast:15 row_mask:0xa bank_mask:0xf
    s_nop 1
    v_add_f32_dpp v36, v36, v36 row_bcast:31 row_mask:0xc bank_mask:0xf
    s_nop 0
    v_readlane_b32 s53, v36, 63
    s_barrier
    v_cvt_pk_bf16_f32 v14, v14, v14
    v_and_b32 v14, s59, v14
    v_mov_b32 v40, 0x3b000000
    v_mul_f32 v40, s53, v40
    v_cvt_pk_bf16_f32 v40, v40, v40
    v_and_b32 v40, s59, v40
    v_add_f32 v40, 0x3727c5ac, v40
    v_cvt_pk_bf16_f32 v40, v40, v40
    v_and_b32 v40, s59, v40
    v_sqrt_f32 v40, v40
    s_nop 0
    v_cvt_pk_bf16_f32 v40, v40, v40
    v_and_b32 v40, s59, v40
    v_rcp_f32 v40, v40
    s_waitcnt vmcnt(16)
    v_lshlrev_b32 v28, 16, v20
    v_and_b32 v29, s59, v20
    v_pk_add_f32 v[28:29], v[28:29], v[14:15] op_sel_hi:[1,0] neg_lo:[0,1] neg_hi:[0,1]
    v_cvt_pk_bf16_f32 v29, v28, v29
    v_lshlrev_b32 v28, 16, v29
    v_and_b32 v29, s59, v29
    v_pk_mul_f32 v[28:29], v[28:29], v[40:41] op_sel_hi:[1,0]
    v_cvt_pk_bf16_f32 v48, v28, v28
    v_cvt_pk_bf16_f32 v49, v29, v29
    v_lshlrev_b32 v30, 16, v21
    v_and_b32 v31, s59, v21
    v_pk_add_f32 v[30:31], v[30:31], v[14:15] op_sel_hi:[1,0] neg_lo:[0,1] neg_hi:[0,1]
    v_cvt_pk_bf16_f32 v31, v30, v31
    v_lshlrev_b32 v30, 16, v31
    v_and_b32 v31, s59, v31
    v_pk_mul_f32 v[30:31], v[30:31], v[40:41] op_sel_hi:[1,0]
    v_cvt_pk_bf16_f32 v50, v30, v30
    v_cvt_pk_bf16_f32 v51, v31, v31
    v_lshlrev_b32 v32, 16, v22
    v_and_b32 v33, s59, v22
    v_pk_add_f32 v[32:33], v[32:33], v[14:15] op_sel_hi:[1,0] neg_lo:[0,1] neg_hi:[0,1]
    v_cvt_pk_bf16_f32 v33, v32, v33
    v_lshlrev_b32 v32, 16, v33
    v_and_b32 v33, s59, v33
    v_pk_mul_f32 v[32:33], v[32:33], v[40:41] op_sel_hi:[1,0]
    v_cvt_pk_bf16_f32 v52, v32, v32
    v_cvt_pk_bf16_f32 v53, v33, v33
    v_lshlrev_b32 v34, 16, v23
    v_and_b32 v35, s59, v23
    v_pk_add_f32 v[34:35], v[34:35], v[14:15] op_sel_hi:[1,0] neg_lo:[0,1] neg_hi:[0,1]
    v_cvt_pk_bf16_f32 v35, v34, v35
    v_lshlrev_b32 v34, 16, v35
    v_and_b32 v35, s59, v35
    v_pk_mul_f32 v[34:35], v[34:35], v[40:41] op_sel_hi:[1,0]
    v_cvt_pk_bf16_f32 v54, v34, v34
    v_cvt_pk_bf16_f32 v55, v35, v35
    v_lshlrev_b32 v28, 16, v24
    v_and_b32 v29, s59, v24
    v_pk_add_f32 v[28:29], v[28:29], v[14:15] op_sel_hi:[1,0] neg_lo:[0,1] neg_hi:[0,1]
    v_cvt_pk_bf16_f32 v29, v28, v29
    v_lshlrev_b32 v28, 16, v29
    v_and_b32 v29, s59, v29
    v_pk_mul_f32 v[28:29], v[28:29], v[40:41] op_sel_hi:[1,0]
    v_cvt_pk_bf16_f32 v56, v28, v28
    v_cvt_pk_bf16_f32 v57, v29, v29
    v_lshlrev_b32 v30, 16, v25
    v_and_b32 v31, s59, v25
    v_pk_add_f32 v[30:31], v[30:31], v[14:15] op_sel_hi:[1,0] neg_lo:[0,1] neg_hi:[0,1]
    v_cvt_pk_bf16_f32 v31, v30, v31
    v_lshlrev_b32 v30, 16, v31
    v_and_b32 v31, s59, v31
    v_pk_mul_f32 v[30:31], v[30:31], v[40:41] op_sel_hi:[1,0]
    v_cvt_pk_bf16_f32 v58, v30, v30
    v_cvt_pk_bf16_f32 v59, v31, v31
    v_lshlrev_b32 v32, 16, v26
    v_and_b32 v33, s59, v26
    v_pk_add_f32 v[32:33], v[32:33], v[14:15] op_sel_hi:[1,0] neg_lo:[0,1] neg_hi:[0,1]
    v_cvt_pk_bf16_f32 v33, v32, v33
    v_lshlrev_b32 v32, 16, v33
    v_and_b32 v33, s59, v33
    v_pk_mul_f32 v[32:33], v[32:33], v[40:41] op_sel_hi:[1,0]
    v_cvt_pk_bf16_f32 v60, v32, v32
    v_cvt_pk_bf16_f32 v61, v33, v33
    v_lshlrev_b32 v34, 16, v27
    v_and_b32 v35, s59, v27
    v_pk_add_f32 v[34:35], v[34:35], v[14:15] op_sel_hi:[1,0] neg_lo:[0,1] neg_hi:[0,1]
    v_cvt_pk_bf16_f32 v35, v34, v35
    v_lshlrev_b32 v34, 16, v35
    v_and_b32 v35, s59, v35
    v_pk_mul_f32 v[34:35], v[34:35], v[40:41] op_sel_hi:[1,0]
    v_cvt_pk_bf16_f32 v62, v34, v34
    v_cvt_pk_bf16_f32 v63, v35, v35
    s_waitcnt lgkmcnt(0)
    s_and_b32 s53, s52, 0xff
    s_add_u32 s51, s53, 1
    s_and_b32 s51, s51, 0xff
    s_bfe_u32 s54, s52, 0x80008
    s_add_u32 s54, s54, 1
    s_and_b32 s54, s54, 0xff
    s_cmp_eq_u32 s54, s53
    s_addc_u32 s54, s54, 0
    s_and_b32 s54, s54, 0xff
    s_lshl_b32 s54, s54, 8
    s_or_b32 s51, s51, s54
    s_bfe_u32 s54, s52, 0x80010
    s_add_u32 s54, s54, 1
    s_and_b32 s54, s54, 0xff
    s_cmp_eq_u32 s54, s53
    s_addc_u32 s54, s54, 0
    s_and_b32 s54, s54, 0xff
    s_lshl_b32 s54, s54, 16
    s_or_b32 s51, s51, s54
    s_bfe_u32 s54, s52, 0x80018
    s_add_u32 s54, s54, 1
    s_and_b32 s54, s54, 0xff
    s_cmp_eq_u32 s54, s53
    s_addc_u32 s54, s54, 0
    s_and_b32 s54, s54, 0xff
    s_lshl_b32 s54, s54, 24
    s_or_b32 s51, s51, s54
    v_lshlrev_b32 v14, 3, v0
    v_add_u32 v14, 24, v14
    v_alignbit_b32 v12, s51, s51, v14
    v_and_b32 v36, v48, v8
    v_and_b32 v37, v48, v9
    v_and_b32 v38, v48, v10
    v_and_b32 v39, v48, v11
    v_and_b32 v40, v49, v8
    v_and_b32 v41, v49, v9
    v_and_b32 v42, v49, v10
    v_and_b32 v43, v49, v11
    s_waitcnt vmcnt(15)
    v_mfma_f32_16x16x32_bf16 v[44:47], v[36:39], v[64:67], 0
    v_and_b32 v36, v50, v8
    v_and_b32 v37, v50, v9
    v_and_b32 v38, v50, v10
    v_and_b32 v39, v50, v11
    s_waitcnt vmcnt(14)
    v_mfma_f32_16x16x32_bf16 v[44:47], v[40:43], v[68:71], v[44:47]
    v_and_b32 v40, v51, v8
    v_and_b32 v41, v51, v9
    v_and_b32 v42, v51, v10
    v_and_b32 v43, v51, v11
    s_waitcnt vmcnt(13)
    v_mfma_f32_16x16x32_bf16 v[44:47], v[36:39], v[72:75], v[44:47]
    v_and_b32 v36, v52, v8
    v_and_b32 v37, v52, v9
    v_and_b32 v38, v52, v10
    v_and_b32 v39, v52, v11
    s_waitcnt vmcnt(12)
    v_mfma_f32_16x16x32_bf16 v[44:47], v[40:43], v[76:79], v[44:47]
    v_and_b32 v40, v53, v8
    v_and_b32 v41, v53, v9
    v_and_b32 v42, v53, v10
    v_and_b32 v43, v53, v11
    s_waitcnt vmcnt(11)
    v_mfma_f32_16x16x32_bf16 v[44:47], v[36:39], v[80:83], v[44:47]
    v_and_b32 v36, v54, v8
    v_and_b32 v37, v54, v9
    v_and_b32 v38, v54, v10
    v_and_b32 v39, v54, v11
    s_waitcnt vmcnt(10)
    v_mfma_f32_16x16x32_bf16 v[44:47], v[40:43], v[84:87], v[44:47]
    v_and_b32 v40, v55, v8
    v_and_b32 v41, v55, v9
    v_and_b32 v42, v55, v10
    v_and_b32 v43, v55, v11
    s_waitcnt vmcnt(9)
    v_mfma_f32_16x16x32_bf16 v[44:47], v[36:39], v[88:91], v[44:47]
    v_and_b32 v36, v56, v8
    v_and_b32 v37, v56, v9
    v_and_b32 v38, v56, v10
    v_and_b32 v39, v56, v11
    s_waitcnt vmcnt(8)
    v_mfma_f32_16x16x32_bf16 v[44:47], v[40:43], v[92:95], v[44:47]
    v_and_b32 v40, v57, v8
    v_and_b32 v41, v57, v9
    v_and_b32 v42, v57, v10
    v_and_b32 v43, v57, v11
    s_waitcnt vmcnt(7)
    v_mfma_f32_16x16x32_bf16 v[44:47], v[36:39], v[96:99], v[44:47]
    v_and_b32 v36, v58, v8
    v_and_b32 v37, v58, v9
    v_and_b32 v38, v58, v10
    v_and_b32 v39, v58, v11
    s_waitcnt vmcnt(6)
    v_mfma_f32_16x16x32_bf16 v[44:47], v[40:43], v[100:103], v[44:47]
    v_and_b32 v40, v59, v8
    v_and_b32 v41, v59, v9
    v_and_b32 v42, v59, v10
    v_and_b32 v43, v59, v11
    s_waitcnt vmcnt(5)
    v_mfma_f32_16x16x32_bf16 v[44:47], v[36:39], v[104:107], v[44:47]
    v_and_b32 v36, v60, v8
    v_and_b32 v37, v60, v9
    v_and_b32 v38, v60, v10
    v_and_b32 v39, v60, v11
    s_waitcnt vmcnt(4)
    v_mfma_f32_16x16x32_bf16 v[44:47], v[40:43], v[108:111], v[44:47]
    v_and_b32 v40, v61, v8
    v_and_b32 v41, v61, v9
    v_and_b32 v42, v61, v10
    v_and_b32 v43, v61, v11
    s_waitcnt vmcnt(3)
    v_mfma_f32_16x16x32_bf16 v[44:47], v[36:39], v[112:115], v[44:47]
    v_and_b32 v36, v62, v8
    v_and_b32 v37, v62, v9
    v_and_b32 v38, v62, v10
    v_and_b32 v39, v62, v11
    s_waitcnt vmcnt(2)
    v_mfma_f32_16x16x32_bf16 v[44:47], v[40:43], v[116:119], v[44:47]
    v_and_b32 v40, v63, v8
    v_and_b32 v41, v63, v9
    v_and_b32 v42, v63, v10
    v_and_b32 v43, v63, v11
    s_waitcnt vmcnt(1)
    v_mfma_f32_16x16x32_bf16 v[44:47], v[36:39], v[120:123], v[44:47]
    s_waitcnt vmcnt(0)
    v_mfma_f32_16x16x32_bf16 v[44:47], v[40:43], v[124:127], v[44:47]
    s_nop 7
    v_mov_b32 v28, v44
    v_mov_b32 v29, v45
    v_mov_b32 v30, v46
    v_mov_b32 v31, v47
    v_permlane32_swap_b32 v44, v28
    v_permlane32_swap_b32 v45, v29
    v_permlane32_swap_b32 v46, v30
    v_permlane32_swap_b32 v47, v31
    v_add_f32_dpp v44, v28, v44 row_ror:8 row_mask:0xf bank_mask:0xf
    v_add_f32_dpp v45, v29, v45 row_ror:8 row_mask:0xf bank_mask:0xf
    v_add_f32_dpp v46, v30, v46 row_ror:8 row_mask:0xf bank_mask:0xf
    v_add_f32_dpp v47, v31, v47 row_ror:8 row_mask:0xf bank_mask:0xf
    v_bfi_b32 v46, s58, v13, v46
    v_bfi_b32 v47, s58, v12, v47
    s_mov_b64 exec, 0x00ff00ff
    buffer_store_dwordx4 v[44:47], v7, s[36:39], s63 offen
    s_add_u32 s63, s63, 1044480
    buffer_store_dwordx4 v[44:47], v7, s[36:39], s63 offen sc1
    s_mov_b64 exec, -1
    s_barrier
    v_and_b32 v14, 8, v0
    v_add_u32_e64 v7, v7, v14
    s_sleep 19
    buffer_load_dwordx4 v[64:67], v4, s[36:39], s62 offen offset:0 sc1
    buffer_load_dwordx4 v[68:71], v4, s[36:39], s62 offen offset:1024 sc1
    buffer_load_dwordx4 v[72:75], v4, s[36:39], s62 offen offset:2048 sc1
    buffer_load_dwordx4 v[76:79], v4, s[36:39], s62 offen offset:3072 sc1
    buffer_load_dwordx4 v[80:83], v4, s[36:39], s64 offen offset:0 sc1
    buffer_load_dwordx4 v[84:87], v4, s[36:39], s64 offen offset:1024 sc1
    buffer_load_dwordx4 v[88:91], v4, s[36:39], s64 offen offset:2048 sc1
    buffer_load_dwordx4 v[92:95], v4, s[36:39], s64 offen offset:3072 sc1
    s_barrier
    s_branch L_qchk
L_qpoll:
    buffer_load_dwordx4 v[64:67], v4, s[36:39], s62 offen offset:0 sc1
    buffer_load_dwordx4 v[68:71], v4, s[36:39], s62 offen offset:1024 sc1
    buffer_load_dwordx4 v[72:75], v4, s[36:39], s62 offen offset:2048 sc1
    buffer_load_dwordx4 v[76:79], v4, s[36:39], s62 offen offset:3072 sc1
    buffer_load_dwordx4 v[80:83], v4, s[36:39], s64 offen offset:0 sc1
    buffer_load_dwordx4 v[84:87], v4, s[36:39], s64 offen offset:1024 sc1
    buffer_load_dwordx4 v[88:91], v4, s[36:39], s64 offen offset:2048 sc1
    buffer_load_dwordx4 v[92:95], v4, s[36:39], s64 offen offset:3072 sc1
L_qchk:
    s_waitcnt vmcnt(0)
L_qchk2:
    v_xor_b32 v14, v67, v12
    v_bitop3_b32 v14, v14, v71, v12 bitop3:0xf6
    v_bitop3_b32 v14, v14, v75, v12 bitop3:0xf6
    v_bitop3_b32 v14, v14, v79, v12 bitop3:0xf6
    v_bitop3_b32 v14, v14, v83, v12 bitop3:0xf6
    v_bitop3_b32 v14, v14, v87, v12 bitop3:0xf6
    v_bitop3_b32 v14, v14, v91, v12 bitop3:0xf6
    v_bitop3_b32 v14, v14, v95, v12 bitop3:0xf6
    v_and_b32 v14, s58, v14
    v_cmp_ne_u32 vcc, 0, v14
    s_cbranch_vccz L_qgo
    s_add_u32 s57, s57, 1
    s_cmp_eq_u32 s57, 1
    s_cselect_b32 s53, 0, 0
    s_cmp_eq_u32 s57, 5
    s_cselect_b32 s53, 1044480, s53
    s_add_u32 s62, s62, s53
    s_add_u32 s64, s64, s53
    s_cmp_lt_u32 s57, 200000
    s_cbranch_scc1 L_qpoll
L_qgo:
    v_xor_b32_e64 v15, v66, v13
    v_bitop3_b32 v15, v15, v74, v13 bitop3:0xf6
    v_pk_add_f32 v[64:65], v[64:65], v[72:73]
    v_pk_add_f32 v[66:67], v[66:67], v[74:75]
    v_bitop3_b32 v15, v15, v82, v13 bitop3:0xf6
    v_pk_add_f32 v[64:65], v[64:65], v[80:81]
    v_pk_add_f32 v[66:67], v[66:67], v[82:83]
    v_bitop3_b32 v15, v15, v90, v13 bitop3:0xf6
    v_pk_add_f32 v[64:65], v[64:65], v[88:89]
    v_pk_add_f32 v[66:67], v[66:67], v[90:91]
    v_cvt_pk_bf16_f32 v64, v64, v65
    v_cvt_pk_bf16_f32 v65, v66, v67
    ds_write_b64 v7, v[64:65] offset:0
    v_bitop3_b32 v15, v15, v70, v13 bitop3:0xf6
    v_bitop3_b32 v15, v15, v78, v13 bitop3:0xf6
    v_pk_add_f32 v[68:69], v[68:69], v[76:77]
    v_pk_add_f32 v[70:71], v[70:71], v[78:79]
    v_bitop3_b32 v15, v15, v86, v13 bitop3:0xf6
    v_pk_add_f32 v[68:69], v[68:69], v[84:85]
    v_pk_add_f32 v[70:71], v[70:71], v[86:87]
    v_bitop3_b32 v15, v15, v94, v13 bitop3:0xf6
    v_pk_add_f32 v[68:69], v[68:69], v[92:93]
    v_pk_add_f32 v[70:71], v[70:71], v[94:95]
    v_cvt_pk_bf16_f32 v68, v68, v69
    v_cvt_pk_bf16_f32 v69, v70, v71
    ds_write_b64 v7, v[68:69] offset:512
    v_and_b32 v15, s58, v15
    v_cmp_ne_u32 vcc, 0, v15
    s_cmp_eq_u64 vcc, 0
    s_cselect_b32 s62, 1, 0
    v_mov_b32 v14, s62
    v_mov_b32 v15, 1024
    ds_write_b32 v15, v14
    s_waitcnt lgkmcnt(0)
    s_barrier
    s_endpgm
.p2align 12
L_kreg:
    s_load_dwordx2 s[20:21], s[0:1], 32
    s_load_dwordx4 s[24:27], s[0:1], 48
    s_load_dwordx4 s[28:31], s[0:1], 64
    v_and_b32 v0, 63, v0
    s_and_b32 s48, s2, 7
    s_lshr_b32 s49, s2, 3
    s_sub_u32 s50, s3, 1
    v_and_b32 v2, 15, v0
    v_lshrrev_b32 v3, 4, v0
    v_and_b32 v6, 7, v2
    v_lshlrev_b32 v4, 8, v6
    v_lshrrev_b32 v6, 3, v2
    v_lshl_add_u32 v4, v6, 6, v4
    v_lshl_add_u32 v4, v3, 4, v4
    v_lshlrev_b32 v5, 10, v3
    v_lshl_add_u32 v5, v2, 4, v5
    s_lshl_b32 s62, s48, 23
    s_lshl_b32 s63, s49, 12
    s_add_u32 s62, s62, s63
    s_lshl_b32 s63, s50, 17
    s_add_u32 s62, s62, s63
    s_add_u32 s62, s62, 7340032
    s_add_u32 s63, s62, 0x80000
    s_mov_b32 s15, 0x20000
    s_lshl_b32 s14, 1, 26
    s_waitcnt lgkmcnt(0)
    s_load_dword s52, s[36:37], 0
    s_mov_b32 s12, s10
    s_mov_b32 s13, s11
    s_mov_b32 s10, s14
    s_mov_b32 s11, s15
    s_mov_b32 s39, s15
    s_lshl_b32 s38, 1, 28
    s_mov_b32 s43, s15
    s_movk_i32 s42, 1024
    s_mov_b32 s44, s30
    s_mov_b32 s45, s31
    s_movk_i32 s46, 1024
    s_mov_b32 s47, s15
    s_mov_b32 s58, 0xff
    s_mov_b32 s59, 0xffff0000
    s_mov_b32 s57, 0
    s_mov_b32 s69, 0x3fb8aa3b
    v_and_b32 v7, 1, v2
    v_lshlrev_b32 v7, 4, v7
    v_mov_b32 v13, 0xffff
    v_lshlrev_b32 v13, v7, v13
    v_bfe_u32 v7, v2, 1, 2
    v_cmp_eq_u32 vcc, 0, v7
    s_nop 1
    v_cndmask_b32 v8, 0, v13, vcc
    v_cmp_eq_u32 vcc, 1, v7
    s_nop 1
    v_cndmask_b32 v9, 0, v13, vcc
    v_cmp_eq_u32 vcc, 2, v7
    s_nop 1
    v_cndmask_b32 v10, 0, v13, vcc
    v_cmp_eq_u32 vcc, 3, v7
    s_nop 1
    v_cndmask_b32 v11, 0, v13, vcc
    v_or_b32 v12, v8, v10
    v_or_b32 v13, v9, v11
    v_and_b32 v15, 1, v3
    v_lshlrev_b32 v15, 1, v15
    v_lshrrev_b32 v6, 1, v3
    v_add_u32 v15, v15, v6
    s_and_b32 s66, s49, 3
    s_lshr_b32 s64, s49, 2
    s_lshl2_add_u32 s56, s48, s64
    s_sub_u32 s67, s64, 4
    s_lshl_b32 s67, s67, 3
    s_add_u32 s67, s67, s48
    s_cmp_lt_u32 s49, 16
    s_cselect_b32 s60, 0, 1
    s_cselect_b32 s67, 0, s67
    s_cmp_ge_u32 s67, 28
    s_cselect_b32 s60, 2, s60
    s_lshl2_add_u32 s55, s67, s66
    v_lshrrev_b32 v6, 2, v2
    v_lshlrev_b32 v16, 8, v6
    v_and_b32 v7, 2, v2
    v_lshl_add_u32 v16, v7, 5, v16
    v_lshl_add_u32 v16, v3, 4, v16
    v_lshlrev_b32 v17, 9, v3
    v_lshl_add_u32 v17, v2, 5, v17
    s_lshl_b32 s64, s50, 11
    s_add_u32 s64, s64, 2304
    v_add_u32 v17, s64, v17
    v_lshlrev_b32 v23, 4, v6
    v_add_u32 v23, 1056, v23
    s_lshl_b32 s64, s50, 2
    v_add_u32 v18, s64, v23
    v_lshlrev_b32 v6, 2, v0
    v_add_u32 v6, 1280, v6
    v_and_b32 v7, 0x33, v0
    v_cmp_eq_u32 vcc, 0, v7
    s_nop 1
    v_cndmask_b32 v18, v6, v18, vcc
    v_lshlrev_b32 v14, 10, v15
    v_lshl_add_u32 v14, v2, 4, v14
    v_lshlrev_b32 v19, 4, v0
    s_barrier
    buffer_load_dwordx4 v[32:35], v4, s[8:11], s62 offen offset:0 nt
    buffer_load_dwordx4 v[36:39], v4, s[8:11], s62 offen offset:128 nt
    buffer_load_dwordx4 v[40:43], v4, s[8:11], s62 offen offset:2048 nt
    buffer_load_dwordx4 v[44:47], v4, s[8:11], s62 offen offset:2176 nt
    s_barrier
    buffer_load_dwordx4 v[48:51], v4, s[8:11], s63 offen offset:0 nt
    buffer_load_dwordx4 v[52:55], v4, s[8:11], s63 offen offset:128 nt
    buffer_load_dwordx4 v[56:59], v4, s[8:11], s63 offen offset:2048 nt
    buffer_load_dwordx4 v[60:63], v4, s[8:11], s63 offen offset:2176 nt
    s_barrier
    s_waitcnt vmcnt(7)
    buffer_load_dwordx4 v[64:67], v5, s[12:15], s62 offen offset:0 nt
    s_waitcnt vmcnt(7)
    buffer_load_dwordx4 v[68:71], v5, s[12:15], s62 offen offset:256 nt
    s_waitcnt vmcnt(7)
    buffer_load_dwordx4 v[72:75], v5, s[12:15], s62 offen offset:512 nt
    s_waitcnt vmcnt(7)
    buffer_load_dwordx4 v[76:79], v5, s[12:15], s62 offen offset:768 nt
    s_waitcnt vmcnt(7)
    buffer_load_dwordx4 v[80:83], v5, s[12:15], s63 offen offset:0 nt
    s_waitcnt vmcnt(7)
    buffer_load_dwordx4 v[84:87], v5, s[12:15], s63 offen offset:256 nt
    s_waitcnt vmcnt(7)
    buffer_load_dwordx4 v[88:91], v5, s[12:15], s63 offen offset:512 nt
    s_waitcnt vmcnt(7)
    buffer_load_dwordx4 v[92:95], v5, s[12:15], s63 offen offset:768 nt
    s_waitcnt lgkmcnt(0)
    s_and_b32 s53, s52, 0xff
    s_add_u32 s51, s53, 1
    s_and_b32 s51, s51, 0xff
    s_bfe_u32 s54, s52, 0x80008
    s_add_u32 s54, s54, 1
    s_and_b32 s54, s54, 0xff
    s_cmp_eq_u32 s54, s53
    s_addc_u32 s54, s54, 0
    s_and_b32 s54, s54, 0xff
    s_lshl_b32 s54, s54, 8
    s_or_b32 s51, s51, s54
    s_bfe_u32 s54, s52, 0x80010
    s_add_u32 s54, s54, 1
    s_and_b32 s54, s54, 0xff
    s_cmp_eq_u32 s54, s53
    s_addc_u32 s54, s54, 0
    s_and_b32 s54, s54, 0xff
    s_lshl_b32 s54, s54, 16
    s_or_b32 s51, s51, s54
    s_bfe_u32 s54, s52, 0x80018
    s_add_u32 s54, s54, 1
    s_and_b32 s54, s54, 0xff
    s_cmp_eq_u32 s54, s53
    s_addc_u32 s54, s54, 0
    s_and_b32 s54, s54, 0xff
    s_lshl_b32 s54, s54, 24
    s_or_b32 s51, s51, s54
    v_lshlrev_b32 v6, 3, v0
    v_alignbit_b32 v24, s51, s51, v6
    v_add_u32 v6, 8, v6
    v_alignbit_b32 v25, s51, s51, v6
    v_add_u32 v6, 8, v6
    v_alignbit_b32 v26, s51, s51, v6
    v_add_u32 v6, 8, v6
    v_alignbit_b32 v27, s51, s51, v6
    s_lshl1_add_u32 s34, s50, s49
    s_and_b32 s34, s34, 7
    s_bfe_u32 s35, s49, 0x20002
    s_lshl2_add_u32 s35, s48, s35
    s_lshl2_add_u32 s35, s35, s50
    s_lshl3_add_u32 s35, s35, s34
    s_lshl4_add_u32 s35, s35, s66
    s_lshl_b32 s35, s35, 8
    s_cmp_eq_u32 s60, 0
    s_cselect_b32 s22, 0x400000, 0
    s_cselect_b32 s64, 0, 0
    s_xor_b32 s35, s35, s64
    s_mov_b32 s23, 0x20000
    s_mov_b32 s33, 0
L_wad:
    s_lshl2_add_u32 s64, s48, s50
    s_lshl_b32 s64, s64, 5
    s_add_u32 s64, s64, s49
    s_lshl_b32 s62, s64, 9
    s_add_u32 s62, s62, 524288
    s_lshl_b32 s63, s64, 4
    s_add_u32 s63, s63, 69632
    s_lshl_b32 s64, s50, 4
    s_add_u32 s64, s64, 1056
    v_mov_b32 v22, s64
    s_lshl_b32 s64, s50, 9
    s_add_u32 s64, s64, 2304
    v_lshl_add_u32 v1, v0, 4, s64
    v_mov_b32 v6, 1024
    v_mov_b32 v20, 0x3db504f3
    v_lshrrev_b32 v6, 3, v0
    v_and_b32 v7, 3, v0
    v_lshl_add_u32 v136, v6, 2, v7
    v_lshlrev_b32 v136, 4, v136
    v_and_b32 v7, 7, v0
    v_xor_b32 v7, s34, v7
    v_lshlrev_b32 v137, 11, v6
    v_lshl_add_u32 v137, v7, 4, v137
    v_lshlrev_b32 v7, 3, v7
    v_add_u32 v7, 24, v7
    v_alignbit_b32 v138, s51, s51, v7
    v_mov_b32 v6, 1024
    v_mov_b32 v142, 0
    v_mov_b32 v143, 0
    s_cmp_lg_u32 s60, 1
    s_cbranch_scc1 L_nwaf
    v_mov_b32 v7, 0
    s_lshl_b32 s65, s66, 7
    s_lshl_b32 s64, s50, 5
    s_add_u32 s65, s65, s64
    s_mul_i32 s65, s65, 3584
    s_lshl_b32 s64, s67, 7
    s_add_u32 s65, s65, s64
    s_movk_i32 s64, 3584
    v_mul_u32_u24 v6, s64, v15
    v_and_b32 v20, 7, v0
    v_lshl_add_u32 v6, v20, 4, v6
    v_add_u32 v6, s65, v6
    v_lshl_add_u64 v[142:143], v[6:7], 0, s[24:25]
    v_lshl_add_u64 v[20:21], v[6:7], 0, s[26:27]
    v_cmp_gt_u32 vcc, 8, v2
    s_nop 1
    v_cndmask_b32 v142, v20, v142, vcc
    v_cndmask_b32_e64 v143, v21, v143, vcc
    s_movk_i32 s32, 14336
    v_mov_b32 v6, 1024
    v_mov_b32 v20, 0x3db504f3
L_nwaf:
    buffer_load_dwordx4 v[96:99], v14, s[20:23], s35 offen nt
    s_xor_b32 s35, s35, 0x1000
    buffer_load_dwordx4 v[100:103], v14, s[20:23], s35 offen nt
    s_xor_b32 s35, s35, 0x3000
    buffer_load_dwordx4 v[104:107], v14, s[20:23], s35 offen nt
    s_xor_b32 s35, s35, 0x1000
    s_barrier
    ds_read_b128 v[144:147], v16 offset:0
    ds_read_b128 v[148:151], v16 offset:128
    ds_read_b32 v6, v6
    s_waitcnt vmcnt(11)
    buffer_load_dwordx4 v[108:111], v14, s[20:23], s35 offen nt
    s_xor_b32 s35, s35, 0x7000
    buffer_load_dwordx4 v[112:115], v14, s[20:23], s35 offen nt
    s_xor_b32 s35, s35, 0x1000
    buffer_load_dwordx4 v[116:119], v14, s[20:23], s35 offen nt
    s_xor_b32 s35, s35, 0x3000
    s_waitcnt lgkmcnt(0)
    s_nop 0
    v_mfma_f32_16x16x32_bf16 v[152:155], v[32:35], v[144:147], 0
    v_mfma_f32_16x16x32_bf16 v[156:159], v[40:43], v[144:147], 0
    v_mfma_f32_16x16x32_bf16 v[160:163], v[48:51], v[144:147], 0
    v_mfma_f32_16x16x32_bf16 v[164:167], v[56:59], v[144:147], 0
    v_mfma_f32_16x16x32_bf16 v[152:155], v[36:39], v[148:151], v[152:155]
    v_mfma_f32_16x16x32_bf16 v[156:159], v[44:47], v[148:151], v[156:159]
    v_mfma_f32_16x16x32_bf16 v[160:163], v[52:55], v[148:151], v[160:163]
    v_mfma_f32_16x16x32_bf16 v[164:167], v[60:63], v[148:151], v[164:167]
    buffer_load_dwordx4 v[120:123], v14, s[20:23], s35 offen nt
    s_xor_b32 s35, s35, 0x1000
    buffer_load_dwordx4 v[124:127], v14, s[20:23], s35 offen nt
    v_readfirstlane_b32 s61, v6
    s_nop 1
    v_permlane32_swap_b32 v152, v156
    v_permlane32_swap_b32 v153, v157
    v_permlane32_swap_b32 v154, v158
    v_permlane32_swap_b32 v155, v159
    v_permlane32_swap_b32 v160, v164
    v_permlane32_swap_b32 v161, v165
    v_permlane32_swap_b32 v162, v166
    v_permlane32_swap_b32 v163, v167
    v_add_f32_dpp v152, v156, v152 quad_perm:[2,3,2,3] row_mask:0xf bank_mask:0xf
    v_add_f32_dpp v153, v157, v153 quad_perm:[2,3,2,3] row_mask:0xf bank_mask:0xf
    v_add_f32_dpp v154, v158, v154 quad_perm:[2,3,2,3] row_mask:0xf bank_mask:0xf
    v_add_f32_dpp v155, v159, v155 quad_perm:[2,3,2,3] row_mask:0xf bank_mask:0xf
    v_add_f32_dpp v160, v164, v160 quad_perm:[2,3,2,3] row_mask:0xf bank_mask:0xf
    v_add_f32_dpp v161, v165, v161 quad_perm:[2,3,2,3] row_mask:0xf bank_mask:0xf
    v_add_f32_dpp v162, v166, v162 quad_perm:[2,3,2,3] row_mask:0xf bank_mask:0xf
    v_add_f32_dpp v163, v167, v163 quad_perm:[2,3,2,3] row_mask:0xf bank_mask:0xf
    v_cvt_pk_bf16_f32 v153, v152, v153
    v_cvt_pk_bf16_f32 v155, v154, v155
    v_cvt_pk_bf16_f32 v161, v160, v161
    v_cvt_pk_bf16_f32 v163, v162, v163
    v_lshlrev_b32 v152, 16, v153
    v_and_b32 v153, s59, v153
    v_lshlrev_b32 v154, 16, v155
    v_and_b32 v155, s59, v155
    v_lshlrev_b32 v160, 16, v161
    v_and_b32 v161, s59, v161
    v_lshlrev_b32 v162, 16, v163
    v_and_b32 v163, s59, v163
    v_pk_mul_f32 v[152:153], v[152:153], v[20:21] op_sel_hi:[1,0]
    v_pk_mul_f32 v[154:155], v[154:155], v[20:21] op_sel_hi:[1,0]
    v_pk_mul_f32 v[160:161], v[160:161], v[20:21] op_sel_hi:[1,0]
    v_pk_mul_f32 v[162:163], v[162:163], v[20:21] op_sel_hi:[1,0]
    v_cvt_pk_bf16_f32 v153, v152, v153
    v_cvt_pk_bf16_f32 v155, v154, v155
    v_cvt_pk_bf16_f32 v161, v160, v161
    v_cvt_pk_bf16_f32 v163, v162, v163
    v_lshlrev_b32 v152, 16, v153
    v_and_b32 v153, s59, v153
    v_lshlrev_b32 v154, 16, v155
    v_and_b32 v155, s59, v155
    v_lshlrev_b32 v160, 16, v161
    v_and_b32 v161, s59, v161
    v_lshlrev_b32 v162, 16, v163
    v_and_b32 v163, s59, v163
    v_max3_f32 v28, v152, v153, v154
    v_max3_f32 v29, v155, v160, v161
    v_max3_f32 v28, v162, v163, v28
    v_max_f32 v28, v28, v29
    v_mov_b32 v29, v28
    s_nop 1
    v_permlane32_swap_b32 v28, v29
    v_max_f32 v28, v28, v29
    v_mov_b32 v29, v28
    s_nop 1
    v_permlane16_swap_b32 v28, v29
    v_max_f32 v28, v28, v29
    ds_write_b32 v18, v28
    s_waitcnt lgkmcnt(0)
    s_barrier
    ds_read_b128 v[28:31], v23
    s_waitcnt lgkmcnt(0)
    v_max3_f32 v28, v28, v29, v30
    v_max_f32 v28, v28, v31
    v_mul_f32 v20, s69, v28
    v_fma_f32 v152, v152, s69, -v20
    v_fma_f32 v153, v153, s69, -v20
    v_fma_f32 v154, v154, s69, -v20
    v_fma_f32 v155, v155, s69, -v20
    v_fma_f32 v160, v160, s69, -v20
    v_fma_f32 v161, v161, s69, -v20
    v_fma_f32 v162, v162, s69, -v20
    v_fma_f32 v163, v163, s69, -v20
    v_exp_f32 v152, v152
    v_exp_f32 v153, v153
    v_exp_f32 v154, v154
    v_exp_f32 v155, v155
    v_exp_f32 v160, v160
    v_exp_f32 v161, v161
    v_exp_f32 v162, v162
    v_exp_f32 v163, v163
    v_pk_add_f32 v[20:21], v[152:153], v[154:155]
    v_pk_add_f32 v[28:29], v[160:161], v[162:163]
    v_pk_add_f32 v[20:21], v[20:21], v[28:29]
    v_add_f32 v20, v20, v21
    v_mov_b32 v21, v20
    s_nop 1
    v_permlane32_swap_b32 v20, v21
    v_add_f32 v20, v20, v21
    v_mov_b32 v21, v20
    s_nop 1
    v_permlane16_swap_b32 v20, v21
    v_add_f32_e64 v20, v20, v21
    ds_write_b32 v18, v20 offset:64
    v_cvt_pk_bf16_f32 v157, v152, v152
    v_cvt_pk_bf16_f32 v159, v153, v153
    v_cvt_pk_bf16_f32 v165, v154, v154
    v_cvt_pk_bf16_f32 v167, v155, v155
    v_cvt_pk_bf16_f32 v145, v160, v160
    v_cvt_pk_bf16_f32 v147, v161, v161
    v_cvt_pk_bf16_f32 v149, v162, v162
    v_cvt_pk_bf16_f32 v151, v163, v163
    v_and_b32_dpp v156, v157, v12 quad_perm:[0,0,0,0] row_mask:0xf bank_mask:0xf
    v_and_b32_dpp v158, v159, v12 quad_perm:[0,0,0,0] row_mask:0xf bank_mask:0xf
    v_and_b32_dpp v164, v165, v12 quad_perm:[0,0,0,0] row_mask:0xf bank_mask:0xf
    v_and_b32_dpp v166, v167, v12 quad_perm:[0,0,0,0] row_mask:0xf bank_mask:0xf
    v_and_b32_dpp v144, v145, v12 quad_perm:[0,0,0,0] row_mask:0xf bank_mask:0xf
    v_and_b32_dpp v146, v147, v12 quad_perm:[0,0,0,0] row_mask:0xf bank_mask:0xf
    v_and_b32_dpp v148, v149, v12 quad_perm:[0,0,0,0] row_mask:0xf bank_mask:0xf
    v_and_b32_dpp v150, v151, v12 quad_perm:[0,0,0,0] row_mask:0xf bank_mask:0xf
    v_and_b32_dpp v157, v157, v13 quad_perm:[0,0,0,0] row_mask:0xf bank_mask:0xf
    v_and_b32_dpp v159, v159, v13 quad_perm:[0,0,0,0] row_mask:0xf bank_mask:0xf
    v_and_b32_dpp v165, v165, v13 quad_perm:[0,0,0,0] row_mask:0xf bank_mask:0xf
    v_and_b32_dpp v167, v167, v13 quad_perm:[0,0,0,0] row_mask:0xf bank_mask:0xf
    v_and_b32_dpp v145, v145, v13 quad_perm:[0,0,0,0] row_mask:0xf bank_mask:0xf
    v_and_b32_dpp v147, v147, v13 quad_perm:[0,0,0,0] row_mask:0xf bank_mask:0xf
    v_and_b32_dpp v149, v149, v13 quad_perm:[0,0,0,0] row_mask:0xf bank_mask:0xf
    v_and_b32_dpp v151, v151, v13 quad_perm:[0,0,0,0] row_mask:0xf bank_mask:0xf
    v_mov_b32 v30, s51
    v_mov_b32 v31, s51
    s_waitcnt lgkmcnt(0)
    s_barrier
    ds_read_b128 v[40:43], v22
    ds_read_b128 v[44:47], v22 offset:64
    s_mov_b64 exec, 1
    s_waitcnt lgkmcnt(0)
    v_max3_f32 v28, v40, v41, v42
    v_max_f32 v28, v28, v43
    v_pk_add_f32 v[44:45], v[44:45], v[46:47]
    v_add_f32 v29, v44, v45
    s_cmp_eq_u32 s61, 1
    s_cbranch_scc0 L_wt_1
    buffer_store_dwordx4 v[28:31], v19, s[36:39], s63 offen
L_wb_2:
    s_mov_b64 exec, -1
    s_waitcnt vmcnt(16)
    v_mfma_f32_16x16x16_bf16 v[32:35], v[156:157], v[64:65], 0
    v_mfma_f32_16x16x16_bf16 v[36:39], v[156:157], v[66:67], 0
    s_waitcnt vmcnt(15)
    v_mfma_f32_16x16x16_bf16 v[32:35], v[158:159], v[68:69], v[32:35]
    v_mfma_f32_16x16x16_bf16 v[36:39], v[158:159], v[70:71], v[36:39]
    s_waitcnt vmcnt(14)
    v_mfma_f32_16x16x16_bf16 v[32:35], v[164:165], v[72:73], v[32:35]
    v_mfma_f32_16x16x16_bf16 v[36:39], v[164:165], v[74:75], v[36:39]
    s_waitcnt vmcnt(13)
    v_mfma_f32_16x16x16_bf16 v[32:35], v[166:167], v[76:77], v[32:35]
    v_mfma_f32_16x16x16_bf16 v[36:39], v[166:167], v[78:79], v[36:39]
    s_waitcnt vmcnt(12)
    v_mfma_f32_16x16x16_bf16 v[32:35], v[144:145], v[80:81], v[32:35]
    v_mfma_f32_16x16x16_bf16 v[36:39], v[144:145], v[82:83], v[36:39]
    s_waitcnt vmcnt(11)
    v_mfma_f32_16x16x16_bf16 v[32:35], v[146:147], v[84:85], v[32:35]
    v_mfma_f32_16x16x16_bf16 v[36:39], v[146:147], v[86:87], v[36:39]
    s_waitcnt vmcnt(10)
    v_mfma_f32_16x16x16_bf16 v[32:35], v[148:149], v[88:89], v[32:35]
    v_mfma_f32_16x16x16_bf16 v[36:39], v[148:149], v[90:91], v[36:39]
    s_waitcnt vmcnt(9)
    v_mfma_f32_16x16x16_bf16 v[32:35], v[150:151], v[92:93], v[32:35]
    v_mfma_f32_16x16x16_bf16 v[36:39], v[150:151], v[94:95], v[36:39]
    s_nop 6
    ds_write_b128 v17, v[32:35]
    ds_write_b128 v17, v[36:39] offset:16
    s_waitcnt lgkmcnt(0)
    s_barrier
    s_mov_b32 exec_hi, 0
    ds_read_b128 v[48:51], v1 offset:0
    ds_read_b128 v[52:55], v1 offset:2048
    ds_read_b128 v[56:59], v1 offset:4096
    ds_read_b128 v[60:63], v1 offset:6144
    s_waitcnt lgkmcnt(2)
    v_pk_add_f32 v[48:49], v[48:49], v[52:53]
    v_pk_add_f32 v[50:51], v[50:51], v[54:55]
    s_waitcnt lgkmcnt(0)
    v_pk_add_f32 v[56:57], v[56:57], v[60:61]
    v_pk_add_f32 v[58:59], v[58:59], v[62:63]
    v_pk_add_f32 v[48:49], v[48:49], v[56:57]
    v_pk_add_f32 v[50:51], v[50:51], v[58:59]
    v_bfi_b32 v51, s58, v27, v51
    s_cmp_eq_u32 s61, 1
    s_cbranch_scc0 L_wt_3
    buffer_store_dwordx4 v[48:51], v19, s[36:39], s62 offen
L_wb_4:
    s_mov_b32 exec_hi, -1
    s_cmp_eq_u32 s60, 0
    s_cbranch_scc1 L_orole
L_frole:
    s_cmp_eq_u32 s60, 2
    s_cbranch_scc1 L_now13
    global_load_dwordx4 v[96:99], v[142:143], off nt
    v_lshl_add_u64 v[142:143], s[32:33], 0, v[142:143]
    global_load_dwordx4 v[100:103], v[142:143], off nt
    v_lshl_add_u64 v[142:143], s[32:33], 0, v[142:143]
    global_load_dwordx4 v[104:107], v[142:143], off nt
    v_lshl_add_u64 v[142:143], s[32:33], 0, v[142:143]
    global_load_dwordx4 v[108:111], v[142:143], off nt
    v_lshl_add_u64 v[142:143], s[32:33], 0, v[142:143]
    global_load_dwordx4 v[112:115], v[142:143], off nt
    v_lshl_add_u64 v[142:143], s[32:33], 0, v[142:143]
    global_load_dwordx4 v[116:119], v[142:143], off nt
    v_lshl_add_u64 v[142:143], s[32:33], 0, v[142:143]
    global_load_dwordx4 v[120:123], v[142:143], off nt
    v_lshl_add_u64 v[142:143], s[32:33], 0, v[142:143]
    global_load_dwordx4 v[124:127], v[142:143], off nt
L_now13:
    s_lshl_b32 s65, s66, 8
    s_lshl_b32 s63, s50, 6
    s_add_u32 s65, s65, s63
    v_and_b32 v7, 7, v0
    v_lshl_add_u32 v6, v7, 2, v15
    v_lshlrev_b32 v6, 1, v6
    buffer_load_short_d16_hi v22, v6, s[40:43], s65 offen
    v_lshlrev_b32 v28, 7, v7
    v_mov_b32 v23, 0x3f803f80
    v_and_b32 v7, 1, v2
    v_lshlrev_b32 v7, 4, v7
    v_mov_b32 v6, 0xffff
    v_lshlrev_b32 v6, v7, v6
    v_and_b32 v23, v23, v6
    v_bfe_u32 v7, v2, 1, 2
    v_cmp_eq_u32 vcc, 0, v7
    s_nop 1
    v_cndmask_b32 v84, 0, v23, vcc
    v_mov_b32 v88, v84
    v_cmp_eq_u32 vcc, 1, v7
    s_nop 1
    v_cndmask_b32 v85, 0, v23, vcc
    v_mov_b32 v89, v85
    v_cmp_eq_u32 vcc, 2, v7
    s_nop 1
    v_cndmask_b32 v86, 0, v23, vcc
    v_mov_b32 v90, v86
    v_cmp_eq_u32 vcc, 3, v7
    s_nop 1
    v_cndmask_b32 v87, 0, v23, vcc
    v_mov_b32 v91, v87
    s_lshr_b32 s7, s48, 2
    s_xor_b32 s7, s7, 0
    s_lshl_b32 s7, s7, 13
    s_lshl_b32 s62, s66, 15
    s_lshl_b32 s63, s50, 7
    s_add_u32 s62, s62, s63
    s_add_u32 s62, s62, 131072
    v_lshrrev_b32 v6, 3, v0
    v_and_b32 v7, 7, v0
    v_lshlrev_b32 v20, 11, v6
    v_lshl_add_u32 v20, v7, 4, v20
    v_and_b32 v6, 32, v0
    v_lshlrev_b32 v6, 8, v6
    v_add_u32 v20, v20, v6
    s_lshl2_add_u32 s53, s55, s50
    s_lshl_b32 s63, s53, 4
    s_add_u32 s63, s63, 86016
    v_and_b32 v5, 3, v0
    v_lshlrev_b32 v5, 4, v5
    v_bfe_u32 v4, v0, 2, 1
    v_lshl_add_u32 v5, v4, 13, v5
    v_bfe_u32 v4, v0, 4, 1
    v_lshl_add_u32 v5, v4, 12, v5
    v_bfe_u32 v4, v0, 3, 1
    v_lshl_add_u32 v5, v4, 7, v5
    v_bfe_u32 v4, v0, 5, 1
    v_lshl_add_u32 v5, v4, 6, v5
    s_lshl_b32 s64, s67, 14
    s_and_b32 s65, s53, 15
    s_lshl_b32 s65, s65, 8
    s_add_u32 s64, s64, s65
    s_add_u32 s64, s64, 1179648
    s_bfe_u32 s53, s49, 0x20002
    s_and_b32 s54, s48, 1
    s_lshl2_add_u32 s53, s54, s53
    s_lshr_b32 s54, s48, 2
    s_lshl3_add_u32 s53, s54, s53
    s_bfe_u32 s54, s48, 0x10001
    s_lshl1_add_u32 s6, s53, s54
    s_lshl1_add_u32 s54, s66, s54
    s_lshl4_add_u32 s5, s54, s53
    s_lshl_b32 s4, s66, 5
    s_add_u32 s4, s4, s6
    s_lshl_b32 s4, s4, 3
    s_lshl_b32 s53, s5, 3
    v_lshlrev_b32 v132, 1, v15
    s_add_u32 s56, s53, 0
    v_mov_b32 v7, s56
    v_alignbit_b32 v128, s51, s51, v7
    s_add_u32 s56, s53, 8
    v_mov_b32 v7, s56
    v_alignbit_b32 v129, s51, s51, v7
    s_add_u32 s56, s53, 16
    v_mov_b32 v7, s56
    v_alignbit_b32 v130, s51, s51, v7
    s_add_u32 s56, s53, 24
    v_mov_b32 v7, s56
    v_alignbit_b32 v131, s51, s51, v7
    s_lshl_b32 s54, s48, 10
    s_add_u32 s54, s54, 98304
    s_sub_u32 s53, s2, 128
    s_lshl2_add_u32 s53, s53, s50
    s_lshl_b32 s53, s53, 1
    s_lshr_b32 s56, s53, 6
    s_lshl_b32 s56, s56, 14
    s_and_b32 s53, s53, 63
    s_lshl_b32 s53, s53, 7
    s_add_u32 s53, s53, s56
    s_add_u32 s53, s53, 262144
    s_add_u32 s92, s36, s53
    s_addc_u32 s93, s37, 0
    s_lshr_b32 s53, s50, 1
    s_mul_i32 s53, s53, 8192
    s_xor_b32 s56, s53, 0x2000
    s_memtime s[84:85]
    s_waitcnt lgkmcnt(0)
    s_load_dword s90, s[92:93], s53 glc
    s_waitcnt lgkmcnt(0)
    s_memtime s[86:87]
    s_waitcnt lgkmcnt(0)
    s_load_dword s90, s[92:93], s56 glc
    s_waitcnt lgkmcnt(0)
    s_memtime s[88:89]
    s_waitcnt lgkmcnt(0)
    s_sub_u32 s88, s88, s86
    s_sub_u32 s86, s86, s84
    s_cmp_eq_u32 s53, 0
    s_cselect_b32 s84, s86, s88
    s_cselect_b32 s85, s88, s86
    v_mov_b32 v6, s84
    v_mov_b32 v7, s85
    s_lshl_b32 s53, s50, 2
    v_mov_b32 v21, s53
    ds_write_b32 v21, v6 offset:1056
    ds_write_b32 v21, v7 offset:1072
    s_waitcnt lgkmcnt(0)
    s_barrier
    v_mov_b32 v7, 0
    ds_read_b128 v[32:35], v7 offset:1056
    ds_read_b128 v[36:39], v7 offset:1072
    s_waitcnt lgkmcnt(0)
    v_min3_u32 v32, v32, v33, v34
    v_min3_u32 v36, v36, v37, v38
    v_min_u32 v32, v32, v35
    v_min_u32 v36, v36, v39
    v_sub_u32 v32, v32, v36
    s_nop 0
    v_readfirstlane_b32 s53, v32
    s_cmp_gt_i32 s53, 0
    s_cselect_b32 s7, 0x2000, 0
    s_sleep 1
    s_add_u32 s54, s54, s7
    s_add_u32 s62, s62, s7
    buffer_load_dword v29, v28, s[36:39], s54 offen sc1
    s_waitcnt vmcnt(0)
    v_cmp_ne_u32 vcc, s51, v29
    s_cbranch_vccz L_fx2
    s_lshl_b32 s54, s48, 10
    s_add_u32 s54, s54, 98304
    s_add_u32 s54, s54, s7
L_fx1:
    buffer_load_dword v29, v28, s[36:39], s54 offen sc1
    s_waitcnt vmcnt(0)
    v_cmp_ne_u32 vcc, s51, v29
    s_cbranch_vccz L_fx1_go
    s_add_u32 s57, s57, 1
    s_cmp_lt_u32 s57, 200000
    s_cbranch_scc1 L_fx1
L_fx1_go:
    s_sleep 5
L_fx2:
    buffer_load_dwordx4 v[52:55], v20, s[36:39], s62 offen offset:0 sc1
    buffer_load_dwordx4 v[56:59], v20, s[36:39], s62 offen offset:512 sc1
    buffer_load_dwordx4 v[60:63], v20, s[36:39], s62 offen offset:1024 sc1
    buffer_load_dwordx4 v[64:67], v20, s[36:39], s62 offen offset:1536 sc1
L_gpoll:
    s_waitcnt vmcnt(0)
    v_xor_b32 v6, v55, v27
    v_bitop3_b32 v6, v6, v59, v27 bitop3:0xf6
    v_bitop3_b32 v6, v6, v63, v27 bitop3:0xf6
    v_bitop3_b32 v6, v6, v67, v27 bitop3:0xf6
    v_and_b32 v6, s58, v6
    v_cmp_ne_u32 vcc, 0, v6
    s_cbranch_vccz L_gpoll_go
    v_or_b32_dpp v6, v6, v6 quad_perm:[1,0,3,2] row_mask:0xf bank_mask:0xf
    s_nop 1
    v_or_b32_dpp v6, v6, v6 quad_perm:[2,3,0,1] row_mask:0xf bank_mask:0xf
    v_cmp_ne_u32_e64 vcc, 0, v6
    s_mov_b64 exec, vcc
    buffer_load_dwordx4 v[52:55], v20, s[36:39], s62 offen offset:0 sc1
    buffer_load_dwordx4 v[56:59], v20, s[36:39], s62 offen offset:512 sc1
    buffer_load_dwordx4 v[60:63], v20, s[36:39], s62 offen offset:1024 sc1
    buffer_load_dwordx4 v[64:67], v20, s[36:39], s62 offen offset:1536 sc1
    s_mov_b64 exec, -1
    s_add_u32 s57, s57, 1
    s_cmp_lt_u32 s57, 200000
    s_cbranch_scc1 L_gpoll
    s_waitcnt vmcnt(0)
L_gpoll_go:
    v_pk_add_f32 v[52:53], v[52:53], v[56:57]
    v_pk_add_f32 v[54:55], v[54:55], v[58:59]
    v_pk_add_f32 v[60:61], v[60:61], v[64:65]
    v_pk_add_f32 v[62:63], v[62:63], v[66:67]
    v_pk_add_f32 v[52:53], v[52:53], v[60:61]
    v_pk_add_f32 v[54:55], v[54:55], v[62:63]
    v_and_b32 v22, s59, v22
    v_permlane32_swap_b32 v52, v53
    v_permlane32_swap_b32 v54, v55
    v_add_f32 v52, v52, v53
    v_add_f32 v54, v54, v55
    s_nop 1
    v_permlane16_swap_b32 v52, v54
    v_add_f32 v52, v52, v54
    s_nop 1
    v_add_f32_dpp v52, v52, v52 row_ror:8 row_mask:0xf bank_mask:0xf
    v_cvt_pk_bf16_f32 v52, v52, v52
    v_and_b32 v52, s59, v52
    v_add_f32 v52, v22, v52
    v_cvt_pk_bf16_f32 v52, v52, v52
    v_and_b32 v22, s59, v52
    s_cmp_eq_u32 s60, 2
    s_cbranch_scc1 L_red
    v_readfirstlane_b32 s53, v22
    s_nop 1
    v_subrev_f32 v6, s53, v22
    v_mul_f32 v7, v6, v6
    s_nop 0
    v_add_f32_dpp v6, v6, v6 row_ror:4 row_mask:0xf bank_mask:0xf
    v_add_f32_dpp v7, v7, v7 row_ror:4 row_mask:0xf bank_mask:0xf
    s_nop 0
    v_add_f32_dpp v6, v6, v6 row_ror:2 row_mask:0xf bank_mask:0xf
    v_add_f32_dpp v7, v7, v7 row_ror:2 row_mask:0xf bank_mask:0xf
    s_nop 0
    v_add_f32_dpp v6, v6, v6 row_ror:1 row_mask:0xf bank_mask:0xf
    v_add_f32_dpp v7, v7, v7 row_ror:1 row_mask:0xf bank_mask:0xf
    s_nop 0
    v_add_f32_dpp v6, v6, v6 row_bcast:15 row_mask:0xa bank_mask:0xf
    v_add_f32_dpp v7, v7, v7 row_bcast:15 row_mask:0xa bank_mask:0xf
    s_nop 0
    v_add_f32_dpp v6, v6, v6 row_bcast:31 row_mask:0xc bank_mask:0xf
    v_add_f32_dpp v7, v7, v7 row_bcast:31 row_mask:0xc bank_mask:0xf
    v_mul_f32 v28, 0x3d000000, v6
    v_fma_f32 v29, -v28, v6, v7
    v_add_f32 v28, s53, v28
    v_mov_b32_e64 v4, 0
    s_mov_b32 exec_lo, 0
    s_mov_b32 exec_hi, 0x80000000
    s_cmp_eq_u32 s61, 1
    s_cbranch_scc0 L_wt_5
    buffer_store_dwordx4 v[28:31], v4, s[36:39], s63 offen
L_wb_6:
    s_mov_b64 exec, -1
    v_and_b32_dpp v84, v52, v8 row_newbcast:0 row_mask:0xf bank_mask:0x3
    v_and_b32_dpp v85, v52, v9 row_newbcast:0 row_mask:0xf bank_mask:0x3
    v_and_b32_dpp v86, v52, v10 row_newbcast:0 row_mask:0xf bank_mask:0x3
    v_and_b32_dpp v87, v52, v11 row_newbcast:0 row_mask:0xf bank_mask:0x3
    v_and_b32_dpp v88, v52, v8 row_newbcast:1 row_mask:0xf bank_mask:0x3
    v_and_b32_dpp v89, v52, v9 row_newbcast:1 row_mask:0xf bank_mask:0x3
    v_and_b32_dpp v90, v52, v10 row_newbcast:1 row_mask:0xf bank_mask:0x3
    v_and_b32_dpp v91, v52, v11 row_newbcast:1 row_mask:0xf bank_mask:0x3
    v_mfma_f32_16x16x32_bf16 v[92:95], v[84:87], v[96:99], 0
    v_and_b32_dpp v84, v52, v8 row_newbcast:2 row_mask:0xf bank_mask:0x3
    v_and_b32_dpp v85, v52, v9 row_newbcast:2 row_mask:0xf bank_mask:0x3
    v_and_b32_dpp v86, v52, v10 row_newbcast:2 row_mask:0xf bank_mask:0x3
    v_and_b32_dpp v87, v52, v11 row_newbcast:2 row_mask:0xf bank_mask:0x3
    v_mfma_f32_16x16x32_bf16 v[92:95], v[88:91], v[100:103], v[92:95]
    v_and_b32_dpp v88, v52, v8 row_newbcast:3 row_mask:0xf bank_mask:0x3
    v_and_b32_dpp v89, v52, v9 row_newbcast:3 row_mask:0xf bank_mask:0x3
    v_and_b32_dpp v90, v52, v10 row_newbcast:3 row_mask:0xf bank_mask:0x3
    v_and_b32_dpp v91, v52, v11 row_newbcast:3 row_mask:0xf bank_mask:0x3
    v_mfma_f32_16x16x32_bf16 v[92:95], v[84:87], v[104:107], v[92:95]
    v_and_b32_dpp v84, v52, v8 row_newbcast:4 row_mask:0xf bank_mask:0x3
    v_and_b32_dpp v85, v52, v9 row_newbcast:4 row_mask:0xf bank_mask:0x3
    v_and_b32_dpp v86, v52, v10 row_newbcast:4 row_mask:0xf bank_mask:0x3
    v_and_b32_dpp v87, v52, v11 row_newbcast:4 row_mask:0xf bank_mask:0x3
    v_mfma_f32_16x16x32_bf16 v[92:95], v[88:91], v[108:111], v[92:95]
    v_and_b32_dpp v88, v52, v8 row_newbcast:5 row_mask:0xf bank_mask:0x3
    v_and_b32_dpp v89, v52, v9 row_newbcast:5 row_mask:0xf bank_mask:0x3
    v_and_b32_dpp v90, v52, v10 row_newbcast:5 row_mask:0xf bank_mask:0x3
    v_and_b32_dpp v91, v52, v11 row_newbcast:5 row_mask:0xf bank_mask:0x3
    v_mfma_f32_16x16x32_bf16 v[92:95], v[84:87], v[112:115], v[92:95]
    v_and_b32_dpp v84, v52, v8 row_newbcast:6 row_mask:0xf bank_mask:0x3
    v_and_b32_dpp v85, v52, v9 row_newbcast:6 row_mask:0xf bank_mask:0x3
    v_and_b32_dpp v86, v52, v10 row_newbcast:6 row_mask:0xf bank_mask:0x3
    v_and_b32_dpp v87, v52, v11 row_newbcast:6 row_mask:0xf bank_mask:0x3
    v_mfma_f32_16x16x32_bf16 v[92:95], v[88:91], v[116:119], v[92:95]
    v_and_b32_dpp v88, v52, v8 row_newbcast:7 row_mask:0xf bank_mask:0x3
    v_and_b32_dpp v89, v52, v9 row_newbcast:7 row_mask:0xf bank_mask:0x3
    v_and_b32_dpp v90, v52, v10 row_newbcast:7 row_mask:0xf bank_mask:0x3
    v_and_b32_dpp v91, v52, v11 row_newbcast:7 row_mask:0xf bank_mask:0x3
    v_mfma_f32_16x16x32_bf16 v[92:95], v[84:87], v[120:123], v[92:95]
    s_nop 0
    v_mfma_f32_16x16x32_bf16 v[92:95], v[88:91], v[124:127], v[92:95]
    s_nop 7
    v_bfi_b32 v95, s58, v27, v95
    s_cmp_eq_u32 s61, 1
    s_cbranch_scc0 L_wt_7
    buffer_store_dwordx4 v[92:95], v5, s[36:39], s64 offen
L_wb_8:
    s_branch L_red
.p2align 12
L_orole:
    s_lshl_b32 s62, s56, 14
    s_add_u32 s62, s62, 524288
    s_lshl_b32 s63, s50, 7
    s_add_u32 s62, s62, s63
    s_lshl_b32 s63, s56, 9
    s_add_u32 s63, s63, 69632
    s_lshl_b32 s64, s50, 10
    s_add_u32 s64, s64, 10496
    v_lshl_add_u32 v22, v0, 4, s64
    v_and_b32 v7, 1, v0
    v_lshlrev_b32 v7, 4, v7
    v_bfe_u32 v1, v0, 1, 4
    v_add_u32 v7, v7, v1
    v_lshlrev_b32 v7, 4, v7
    v_and_b32 v1, 31, v0
    v_lshlrev_b32 v1, 4, v1
    v_lshrrev_b32 v4, 5, v0
    v_lshl_add_u32 v1, v4, 13, v1
    buffer_load_dwordx4 v[52:55], v136, s[36:39], s63 offen sc1
    buffer_load_dwordx4 v[32:35], v137, s[36:39], s62 offen offset:0 sc1
    buffer_load_dwordx4 v[36:39], v137, s[36:39], s62 offen offset:512 sc1
    buffer_load_dwordx4 v[40:43], v137, s[36:39], s62 offen offset:1024 sc1
    buffer_load_dwordx4 v[44:47], v137, s[36:39], s62 offen offset:1536 sc1
L_mpoll:
    s_waitcnt vmcnt(0)
    v_xor_b32 v6, v35, v138
    v_bitop3_b32 v6, v6, v39, v138 bitop3:0xf6
    v_bitop3_b32 v6, v6, v43, v138 bitop3:0xf6
    v_bitop3_b32 v6, v6, v47, v138 bitop3:0xf6
    v_and_b32 v6, s58, v6
    v_cmp_ne_u32 s[96:97], s51, v55
    v_bitop3_b32 v6, v6, v55, s51 bitop3:0xf6
    s_nop 1
    v_or_b32_dpp v6, v6, v6 quad_perm:[1,0,3,2] row_mask:0xf bank_mask:0xf
    s_nop 1
    v_or_b32_dpp v6, v6, v6 quad_perm:[2,3,0,1] row_mask:0xf bank_mask:0xf
    v_cmp_ne_u32 vcc, 0, v6
    s_cbranch_vccz L_mgo
    s_mov_b64 exec, vcc
    buffer_load_dwordx4 v[32:35], v137, s[36:39], s62 offen offset:0 sc1
    buffer_load_dwordx4 v[36:39], v137, s[36:39], s62 offen offset:512 sc1
    buffer_load_dwordx4 v[40:43], v137, s[36:39], s62 offen offset:1024 sc1
    buffer_load_dwordx4 v[44:47], v137, s[36:39], s62 offen offset:1536 sc1
    s_cmp_eq_u64 s[96:97], 0
    s_cbranch_scc1 L_mgo
    buffer_load_dwordx4 v[52:55], v136, s[36:39], s63 offen sc1
    s_mov_b64 exec, -1
    s_add_u32 s57, s57, 1
    s_cmp_lt_u32 s57, 200000
    s_cbranch_scc1 L_mpoll
    s_waitcnt vmcnt(0)
L_mgo:
    s_mov_b64 exec, -1
    v_max_f32_dpp v6, v52, v52 quad_perm:[1,0,3,2] row_mask:0xf bank_mask:0xf
    s_nop 1
    v_max_f32_dpp v6, v6, v6 quad_perm:[2,3,0,1] row_mask:0xf bank_mask:0xf
    s_nop 1
    v_max_f32_dpp v6, v6, v6 row_ror:8 row_mask:0xf bank_mask:0xf
    s_nop 1
    v_max_f32_dpp v6, v6, v6 row_bcast:15 row_mask:0xa bank_mask:0xf
    s_nop 1
    v_max_f32_dpp v6, v6, v6 row_bcast:31 row_mask:0xc bank_mask:0xf
    s_nop 0
    v_readlane_b32 s53, v6, 63
    s_nop 1
    v_subrev_f32 v52, s53, v52
    v_mul_f32 v52, s69, v52
    v_exp_f32 v52, v52
    s_nop 0
    v_mul_f32 v6, v52, v53
    s_nop 1
    v_add_f32_dpp v6, v6, v6 quad_perm:[1,0,3,2] row_mask:0xf bank_mask:0xf
    s_nop 1
    v_add_f32_dpp v6, v6, v6 quad_perm:[2,3,0,1] row_mask:0xf bank_mask:0xf
    s_nop 1
    v_add_f32_dpp v6, v6, v6 row_ror:8 row_mask:0xf bank_mask:0xf
    s_nop 1
    v_add_f32_dpp v6, v6, v6 row_bcast:15 row_mask:0xa bank_mask:0xf
    s_nop 1
    v_add_f32_dpp v6, v6, v6 row_bcast:31 row_mask:0xc bank_mask:0xf
    s_nop 0
    v_readlane_b32 s53, v6, 63
    s_nop 1
    v_rcp_f32 v6, s53
    s_nop 0
    v_mul_f32 v52, v52, v6
L_opoll:
    s_waitcnt vmcnt(0)
    v_xor_b32 v6, v35, v138
    v_bitop3_b32 v6, v6, v39, v138 bitop3:0xf6
    v_bitop3_b32 v6, v6, v43, v138 bitop3:0xf6
    v_bitop3_b32 v6, v6, v47, v138 bitop3:0xf6
    v_and_b32 v6, s58, v6
    v_cmp_ne_u32 vcc, 0, v6
    s_cbranch_vccz L_opoll_go
    v_or_b32_dpp v6, v6, v6 quad_perm:[1,0,3,2] row_mask:0xf bank_mask:0xf
    s_nop 1
    v_or_b32_dpp v6, v6, v6 quad_perm:[2,3,0,1] row_mask:0xf bank_mask:0xf
    v_cmp_ne_u32 vcc, 0, v6
    s_mov_b64 exec, vcc
    buffer_load_dwordx4 v[32:35], v137, s[36:39], s62 offen offset:0 sc1
    buffer_load_dwordx4 v[36:39], v137, s[36:39], s62 offen offset:512 sc1
    buffer_load_dwordx4 v[40:43], v137, s[36:39], s62 offen offset:1024 sc1
    buffer_load_dwordx4 v[44:47], v137, s[36:39], s62 offen offset:1536 sc1
    s_mov_b64 exec, -1
    s_add_u32 s57, s57, 1
    s_cmp_lt_u32 s57, 200000
    s_cbranch_scc1 L_opoll
    s_waitcnt vmcnt(0)
L_opoll_go:
    v_mul_f32_dpp v80, v52, v32 quad_perm:[0,0,0,0] row_mask:0xf bank_mask:0xf
    v_mul_f32_dpp v81, v52, v33 quad_perm:[0,0,0,0] row_mask:0xf bank_mask:0xf
    v_mul_f32_dpp v82, v52, v34 quad_perm:[0,0,0,0] row_mask:0xf bank_mask:0xf
    v_mul_f32_dpp v83, v52, v35 quad_perm:[0,0,0,0] row_mask:0xf bank_mask:0xf
    v_fmac_f32_dpp v80, v52, v36 quad_perm:[1,1,1,1] row_mask:0xf bank_mask:0xf
    v_fmac_f32_dpp v81, v52, v37 quad_perm:[1,1,1,1] row_mask:0xf bank_mask:0xf
    v_fmac_f32_dpp v82, v52, v38 quad_perm:[1,1,1,1] row_mask:0xf bank_mask:0xf
    v_fmac_f32_dpp v83, v52, v39 quad_perm:[1,1,1,1] row_mask:0xf bank_mask:0xf
    v_fmac_f32_dpp v80, v52, v40 quad_perm:[2,2,2,2] row_mask:0xf bank_mask:0xf
    v_fmac_f32_dpp v81, v52, v41 quad_perm:[2,2,2,2] row_mask:0xf bank_mask:0xf
    v_fmac_f32_dpp v82, v52, v42 quad_perm:[2,2,2,2] row_mask:0xf bank_mask:0xf
    v_fmac_f32_dpp v83, v52, v43 quad_perm:[2,2,2,2] row_mask:0xf bank_mask:0xf
    v_fmac_f32_dpp v80, v52, v44 quad_perm:[3,3,3,3] row_mask:0xf bank_mask:0xf
    v_fmac_f32_dpp v81, v52, v45 quad_perm:[3,3,3,3] row_mask:0xf bank_mask:0xf
    v_fmac_f32_dpp v82, v52, v46 quad_perm:[3,3,3,3] row_mask:0xf bank_mask:0xf
    v_fmac_f32_dpp v83, v52, v47 quad_perm:[3,3,3,3] row_mask:0xf bank_mask:0xf
L_oj:
    s_lshl2_add_u32 s53, s49, s50
    s_cmp_lg_u32 s53, 3
    s_cbranch_scc1 L_nx1
    s_lshl_b32 s54, s48, 7
    s_add_u32 s54, s54, 98304
    v_lshlrev_b32 v5, 10, v0
    s_mov_b64 exec, 0xffff
    buffer_store_dword v30, v5, s[36:39], s54 offen sc1
    s_mov_b64 exec, -1
L_nx1:
    v_permlane32_swap_b32 v80, v81
    v_permlane32_swap_b32 v82, v83
    v_add_f32 v80, v80, v81
    v_add_f32 v82, v82, v83
    s_nop 1
    v_permlane16_swap_b32 v80, v82
    v_add_f32_e64 v80, v80, v82
    s_nop 1
    v_add_f32_dpp v80, v80, v80 row_ror:8 row_mask:0xf bank_mask:0xf
    v_cvt_pk_bf16_f32 v80, v80, v80
    s_nop 1
    v_and_b32_dpp v84, v80, v8 row_newbcast:0 row_mask:0xf bank_mask:0xf
    v_and_b32_dpp v85, v80, v9 row_newbcast:0 row_mask:0xf bank_mask:0xf
    v_and_b32_dpp v86, v80, v10 row_newbcast:0 row_mask:0xf bank_mask:0xf
    v_and_b32_dpp v87, v80, v11 row_newbcast:0 row_mask:0xf bank_mask:0xf
    v_and_b32_dpp v88, v80, v8 row_newbcast:1 row_mask:0xf bank_mask:0xf
    v_and_b32_dpp v89, v80, v9 row_newbcast:1 row_mask:0xf bank_mask:0xf
    v_and_b32_dpp v90, v80, v10 row_newbcast:1 row_mask:0xf bank_mask:0xf
    v_and_b32_dpp v91, v80, v11 row_newbcast:1 row_mask:0xf bank_mask:0xf
    v_mfma_f32_16x16x32_bf16 v[92:95], v[84:87], v[96:99], 0
    v_and_b32_dpp v84, v80, v8 row_newbcast:2 row_mask:0xf bank_mask:0xf
    v_and_b32_dpp v85, v80, v9 row_newbcast:2 row_mask:0xf bank_mask:0xf
    v_and_b32_dpp v86, v80, v10 row_newbcast:2 row_mask:0xf bank_mask:0xf
    v_and_b32_dpp v87, v80, v11 row_newbcast:2 row_mask:0xf bank_mask:0xf
    v_mfma_f32_16x16x32_bf16 v[92:95], v[88:91], v[100:103], v[92:95]
    v_and_b32_dpp v88, v80, v8 row_newbcast:3 row_mask:0xf bank_mask:0xf
    v_and_b32_dpp v89, v80, v9 row_newbcast:3 row_mask:0xf bank_mask:0xf
    v_and_b32_dpp v90, v80, v10 row_newbcast:3 row_mask:0xf bank_mask:0xf
    v_and_b32_dpp v91, v80, v11 row_newbcast:3 row_mask:0xf bank_mask:0xf
    v_mfma_f32_16x16x32_bf16 v[92:95], v[84:87], v[104:107], v[92:95]
    v_and_b32_dpp v84, v80, v8 row_newbcast:4 row_mask:0xf bank_mask:0xf
    v_and_b32_dpp v85, v80, v9 row_newbcast:4 row_mask:0xf bank_mask:0xf
    v_and_b32_dpp v86, v80, v10 row_newbcast:4 row_mask:0xf bank_mask:0xf
    v_and_b32_dpp v87, v80, v11 row_newbcast:4 row_mask:0xf bank_mask:0xf
    v_mfma_f32_16x16x32_bf16 v[92:95], v[88:91], v[108:111], v[92:95]
    v_and_b32_dpp v88, v80, v8 row_newbcast:5 row_mask:0xf bank_mask:0xf
    v_and_b32_dpp v89, v80, v9 row_newbcast:5 row_mask:0xf bank_mask:0xf
    v_and_b32_dpp v90, v80, v10 row_newbcast:5 row_mask:0xf bank_mask:0xf
    v_and_b32_dpp v91, v80, v11 row_newbcast:5 row_mask:0xf bank_mask:0xf
    v_mfma_f32_16x16x32_bf16 v[92:95], v[84:87], v[112:115], v[92:95]
    v_and_b32_dpp v84, v80, v8 row_newbcast:6 row_mask:0xf bank_mask:0xf
    v_and_b32_dpp v85, v80, v9 row_newbcast:6 row_mask:0xf bank_mask:0xf
    v_and_b32_dpp v86, v80, v10 row_newbcast:6 row_mask:0xf bank_mask:0xf
    v_and_b32_dpp v87, v80, v11 row_newbcast:6 row_mask:0xf bank_mask:0xf
    v_mfma_f32_16x16x32_bf16 v[92:95], v[88:91], v[116:119], v[92:95]
    v_and_b32_dpp v88, v80, v8 row_newbcast:7 row_mask:0xf bank_mask:0xf
    v_and_b32_dpp v89, v80, v9 row_newbcast:7 row_mask:0xf bank_mask:0xf
    v_and_b32_dpp v90, v80, v10 row_newbcast:7 row_mask:0xf bank_mask:0xf
    v_and_b32_dpp v91, v80, v11 row_newbcast:7 row_mask:0xf bank_mask:0xf
    v_mfma_f32_16x16x32_bf16 v[92:95], v[84:87], v[120:123], v[92:95]
    s_nop 0
    v_mfma_f32_16x16x32_bf16 v[92:95], v[88:91], v[124:127], v[92:95]
    s_lshr_b32 s63, s56, 4
    s_lshl1_add_u32 s62, s66, s63
    s_lshl_b32 s62, s62, 5
    s_and_b32 s63, s56, 15
    s_add_u32 s62, s62, s63
    s_lshl_b32 s62, s62, 9
    s_add_u32 s62, s62, 131072
    s_lshr_b32 s67, s49, 2
    s_lshl3_add_u32 s67, s67, s48
    s_lshl2_add_u32 s55, s67, s66
    ds_write_b128 v22, v[92:95]
    s_waitcnt lgkmcnt(0)
    s_barrier
    s_cmp_lg_u32 s50, 0
    s_cbranch_scc1 L_onot0
    ds_read_b128 v[112:115], v7 offset:10496
    ds_read_b128 v[116:119], v7 offset:11520
    ds_read_b128 v[120:123], v7 offset:12544
    ds_read_b128 v[124:127], v7 offset:13568
    s_waitcnt lgkmcnt(2)
    v_pk_add_f32 v[112:113], v[112:113], v[116:117]
    v_pk_add_f32 v[114:115], v[114:115], v[118:119]
    s_waitcnt lgkmcnt(0)
    v_pk_add_f32 v[120:121], v[120:121], v[124:125]
    v_pk_add_f32 v[122:123], v[122:123], v[126:127]
    v_pk_add_f32 v[112:113], v[112:113], v[120:121]
    v_pk_add_f32 v[114:115], v[114:115], v[122:123]
    v_bfi_b32 v112, s58, v24, v112
    v_bfi_b32 v113, s58, v25, v113
    v_bfi_b32 v114, s58, v26, v114
    v_bfi_b32 v115, s58, v27, v115
    buffer_store_dwordx4 v[112:115], v1, s[36:39], s62 offen sc1
    s_mov_b32 exec_hi, -1
L_onot0:
    s_barrier
    s_cmp_ge_u32 s67, 28
    s_cbranch_scc1 L_kdone
    s_lshr_b32 s62, s66, 1
    s_and_b32 s63, s66, 1
    s_lshl1_add_u32 s62, s67, s62
    s_lshl3_add_u32 s62, s62, s63
    s_lshl_b32 s62, s62, 12
    s_lshl_b32 s63, s50, 8
    s_add_u32 s62, s62, s63
    s_add_u32 s28, s28, s62
    s_addc_u32 s29, s29, 0
    global_load_dwordx4 v[96:99], v14, s[28:29] nt
    v_add_u32 v14, 0x2000, v14
    global_load_dwordx4 v[100:103], v14, s[28:29] nt
    v_add_u32 v14, 0x2000, v14
    global_load_dwordx4 v[104:107], v14, s[28:29] nt
    v_add_u32 v14, 0x2000, v14
    global_load_dwordx4 v[108:111], v14, s[28:29] nt
L_f2:
    s_lshl_b32 s64, s67, 8
    s_add_u32 s64, s64, 86016
    v_lshlrev_b32 v21, 4, v2
    s_lshl_b32 s62, s55, 12
    s_add_u32 s62, s62, 1179648
    s_lshl2_add_u32 s63, s55, s50
    s_lshl_b32 s65, s63, 9
    s_add_u32 s65, s65, 278528
    s_lshr_b32 s65, s55, 1
    s_and_b32 s63, s65, -2
    s_add_u32 s65, s65, s63
    s_lshl2_add_u32 s65, s65, s50
    s_lshl_b32 s65, s65, 4
    s_and_b32 s63, s55, 1
    s_add_u32 s65, s65, s63
    s_lshl_b32 s65, s65, 6
    s_add_u32 s65, s65, 1638400
    v_bfe_u32 v4, v0, 2, 3
    v_and_b32 v5, 3, v0
    v_lshlrev_b32 v5, 4, v5
    v_lshl_add_u32 v20, v4, 7, v5
    v_lshrrev_b32 v4, 5, v0
    v_lshl_add_u32 v20, v4, 13, v20
    s_lshl4_add_u32 s5, s48, s49
    s_lshl2_add_u32 s5, s5, s50
    s_lshl_b32 s5, s5, 2
    s_add_u32 s5, s5, 2048
    v_and_b32 v6, 7, v0
    v_lshlrev_b32 v6, 7, v6
    s_lshl_b32 s63, s50, 10
    s_add_u32 s63, s63, s62
    buffer_load_dword v7, v6, s[36:39], s63 offen sc1
L_spoll:
    buffer_load_dwordx4 v[36:39], v21, s[36:39], s64 offen sc1
    s_waitcnt vmcnt(0)
    v_cmp_ne_u32 vcc, s51, v39
    s_cbranch_vccz L_sgo
    s_add_u32 s57, s57, 1
    s_cmp_lt_u32 s57, 200000
    s_cbranch_scc1 L_spoll
L_sgo:
    buffer_load_dwordx4 v[64:67], v19, s[36:39], s62 offen offset:0 sc1
    buffer_load_dwordx4 v[68:71], v19, s[36:39], s62 offen offset:1024 sc1
    buffer_load_dwordx4 v[72:75], v19, s[36:39], s62 offen offset:2048 sc1
    buffer_load_dwordx4 v[76:79], v19, s[36:39], s62 offen offset:3072 sc1
    v_add_f32_dpp v6, v36, v36 row_ror:8 row_mask:0xf bank_mask:0xf
    s_nop 1
    v_add_f32_dpp v6, v6, v6 row_ror:4 row_mask:0xf bank_mask:0xf
    s_nop 1
    v_add_f32_dpp v6, v6, v6 row_ror:2 row_mask:0xf bank_mask:0xf
    s_nop 1
    v_add_f32_dpp v6, v6, v6 row_ror:1 row_mask:0xf bank_mask:0xf
    v_mul_f32 v6, 0x3d800000, v6
    v_sub_f32 v36, v36, v6
    v_mul_f32 v36, v36, v36
    v_fmac_f32 v37, 0x42000000, v36
    s_nop 1
    v_add_f32_dpp v37, v37, v37 row_ror:8 row_mask:0xf bank_mask:0xf
    s_nop 1
    v_add_f32_dpp v37, v37, v37 row_ror:4 row_mask:0xf bank_mask:0xf
    s_nop 1
    v_add_f32_dpp v37, v37, v37 row_ror:2 row_mask:0xf bank_mask:0xf
    s_nop 1
    v_add_f32_dpp v37, v37, v37 row_ror:1 row_mask:0xf bank_mask:0xf
    v_cvt_pk_bf16_f32 v6, v6, v6
    v_and_b32 v6, s59, v6
    v_mul_f32 v37, 0x3b000000, v37
    v_sub_f32 v6, 0, v6
    v_cvt_pk_bf16_f32 v37, v37, v37
    v_and_b32 v37, s59, v37
    v_add_f32 v37, 0x3727c5ac, v37
    v_cvt_pk_bf16_f32 v37, v37, v37
    v_and_b32 v37, s59, v37
    v_sqrt_f32 v37, v37
    s_nop 0
    v_cvt_pk_bf16_f32 v37, v37, v37
    v_and_b32 v37, s59, v37
    v_rcp_f32 v37, v37
L_upoll:
    s_waitcnt vmcnt(0)
    v_xor_b32 v7, v67, v27
    v_bitop3_b32 v7, v7, v71, v27 bitop3:0xf6
    v_bitop3_b32 v7, v7, v75, v27 bitop3:0xf6
    v_bitop3_b32 v7, v7, v79, v27 bitop3:0xf6
    v_and_b32 v7, s58, v7
    v_cmp_ne_u32 vcc, 0, v7
    s_cbranch_vccz L_upoll_go
    v_or_b32_dpp v7, v7, v7 quad_perm:[1,0,3,2] row_mask:0xf bank_mask:0xf
    s_nop 1
    v_or_b32_dpp v7, v7, v7 quad_perm:[2,3,0,1] row_mask:0xf bank_mask:0xf
    v_cmp_ne_u32 vcc, 0, v7
    s_mov_b64 exec, vcc
    buffer_load_dwordx4 v[64:67], v19, s[36:39], s62 offen offset:0 sc1
    buffer_load_dwordx4 v[68:71], v19, s[36:39], s62 offen offset:1024 sc1
    buffer_load_dwordx4 v[72:75], v19, s[36:39], s62 offen offset:2048 sc1
    buffer_load_dwordx4 v[76:79], v19, s[36:39], s62 offen offset:3072 sc1
    s_mov_b64 exec, -1
    s_add_u32 s57, s57, 1
    s_cmp_lt_u32 s57, 200000
    s_cbranch_scc1 L_upoll
    s_waitcnt vmcnt(0)
L_upoll_go:
    v_pk_add_f32 v[32:33], v[64:65], v[68:69]
    v_pk_add_f32 v[34:35], v[66:67], v[70:71]
    v_pk_add_f32 v[72:73], v[72:73], v[76:77]
    v_pk_add_f32 v[74:75], v[74:75], v[78:79]
    v_pk_add_f32 v[32:33], v[32:33], v[72:73]
    v_pk_add_f32 v[34:35], v[34:35], v[74:75]
    s_nop 0
    v_permlane32_swap_b32 v32, v33
    v_permlane32_swap_b32 v34, v35
    v_add_f32 v32, v32, v33
    v_add_f32 v34, v34, v35
    s_nop 1
    v_permlane16_swap_b32 v32, v34
    v_add_f32 v32, v32, v34
    s_nop 1
    v_fmac_f32_dpp v32, v32, v6 row_shl:4 row_mask:0xf bank_mask:0xf
    v_mul_f32 v33, v32, v37
    v_cvt_pk_bf16_f32 v33, v33, v33
    v_and_b32 v33, s59, v33
    v_mul_f32 v34, 0xbfb8aa3b, v33
    v_exp_f32 v34, v34
    s_nop 0
    v_add_f32 v34, 1.0, v34
    v_rcp_f32 v34, v34
    s_nop 0
    v_mul_f32 v34, v33, v34
    v_cvt_pk_bf16_f32 v34, v34, v34
    v_and_b32 v34, s59, v34
    s_nop 1
    v_mul_f32_dpp v34, v33, v34 row_shl:8 row_mask:0xf bank_mask:0xf
    v_cvt_pk_bf16_f32 v34, v34, v34
    s_nop 1
    v_and_b32_dpp v84, v34, v8 row_newbcast:0 row_mask:0xf bank_mask:0xf
    v_and_b32_dpp v85, v34, v9 row_newbcast:0 row_mask:0xf bank_mask:0xf
    v_and_b32_dpp v86, v34, v10 row_newbcast:0 row_mask:0xf bank_mask:0xf
    v_and_b32_dpp v87, v34, v11 row_newbcast:0 row_mask:0xf bank_mask:0xf
    v_and_b32_dpp v88, v34, v8 row_newbcast:1 row_mask:0xf bank_mask:0xf
    v_and_b32_dpp v89, v34, v9 row_newbcast:1 row_mask:0xf bank_mask:0xf
    v_and_b32_dpp v90, v34, v10 row_newbcast:1 row_mask:0xf bank_mask:0xf
    v_and_b32_dpp v91, v34, v11 row_newbcast:1 row_mask:0xf bank_mask:0xf
    v_mfma_f32_16x16x32_bf16 v[92:95], v[84:87], v[96:99], 0
    v_and_b32_dpp v84, v34, v8 row_newbcast:2 row_mask:0xf bank_mask:0xf
    v_and_b32_dpp v85, v34, v9 row_newbcast:2 row_mask:0xf bank_mask:0xf
    v_and_b32_dpp v86, v34, v10 row_newbcast:2 row_mask:0xf bank_mask:0xf
    v_and_b32_dpp v87, v34, v11 row_newbcast:2 row_mask:0xf bank_mask:0xf
    v_mfma_f32_16x16x32_bf16 v[92:95], v[88:91], v[100:103], v[92:95]
    v_and_b32_dpp v88, v34, v8 row_newbcast:3 row_mask:0xf bank_mask:0xf
    v_and_b32_dpp v89, v34, v9 row_newbcast:3 row_mask:0xf bank_mask:0xf
    v_and_b32_dpp v90, v34, v10 row_newbcast:3 row_mask:0xf bank_mask:0xf
    v_and_b32_dpp v91, v34, v11 row_newbcast:3 row_mask:0xf bank_mask:0xf
    v_mfma_f32_16x16x32_bf16 v[92:95], v[84:87], v[104:107], v[92:95]
    s_nop 0
    v_mfma_f32_16x16x32_bf16 v[92:95], v[88:91], v[108:111], v[92:95]
    s_nop 7
    v_bfi_b32 v92, s58, v24, v92
    v_bfi_b32 v93, s58, v25, v93
    v_bfi_b32 v94, s58, v26, v94
    v_bfi_b32 v95, s58, v27, v95
    buffer_store_dwordx4 v[92:95], v20, s[36:39], s65 offen sc1
    s_mov_b32 exec_hi, -1
    s_mov_b64 exec, 1
    s_cmp_eq_u32 s61, 1
    s_cbranch_scc0 L_wt_9
    buffer_store_dword v30, v19, s[36:39], s5 offen
L_wb_10:
    s_mov_b64 exec, -1
    s_branch L_kdone
L_red:
    s_lshr_b32 s53, s6, 3
    s_cmp_lg_u32 s53, s50
    s_cbranch_scc1 L_kdone
    s_lshr_b32 s62, s5, 2
    s_lshl_b32 s62, s62, 3
    s_and_b32 s63, s5, 3
    s_add_u32 s62, s62, s63
    s_lshl_b32 s62, s62, 4
    v_lshrrev_b32 v6, 1, v0
    v_and_b32 v7, -2, v6
    v_add_u32 v6, v6, v7
    v_lshlrev_b32 v6, 12, v6
    v_and_b32 v7, 1, v0
    v_lshl_add_u32 v6, v7, 6, v6
    s_add_u32 s62, s62, s7
    s_add_u32 s62, s62, 1638400
    s_add_u32 s63, s62, 262144
    s_lshl_b32 s65, s48, 8
    s_add_u32 s65, s65, 2048
    s_cmp_lt_u32 s48, 4
    s_cselect_b32 s54, 63, 47
    v_min_u32 v28, s54, v0
    v_lshlrev_b32 v28, 2, v28
    s_and_b32 s53, s6, 7
    s_lshl_b32 s6, 0x00010001, s53
    v_and_b32 v36, s58, v128
    v_and_b32 v37, s58, v129
    v_and_b32 v38, s58, v130
    v_and_b32 v39, s58, v131
L_rx2:
    buffer_load_dword v29, v28, s[36:39], s65 offen sc1
    s_waitcnt vmcnt(0)
    v_cmp_ne_u32 vcc, s51, v29
    s_cbranch_vccz L_rx2_go
    s_add_u32 s57, s57, 1
    s_cmp_lt_u32 s57, 200000
    s_cbranch_scc1 L_rx2
L_rx2_go:
    buffer_load_dwordx4 v[32:35], v6, s[36:39], s62 offen sc1
    s_and_b32 exec_hi, exec_hi, 0xffff
    buffer_load_dwordx4 v[36:39], v6, s[36:39], s63 offen sc1
    s_mov_b32 exec_hi, -1
L_fpoll:
    s_waitcnt vmcnt(0)
    v_xor_b32 v7, v32, v128
    v_bitop3_b32 v7, v7, v33, v129 bitop3:0xf6
    v_bitop3_b32 v7, v7, v34, v130 bitop3:0xf6
    v_bitop3_b32 v7, v7, v35, v131 bitop3:0xf6
    v_bitop3_b32 v7, v7, v36, v128 bitop3:0xf6
    v_bitop3_b32 v7, v7, v37, v129 bitop3:0xf6
    v_bitop3_b32 v7, v7, v38, v130 bitop3:0xf6
    v_bitop3_b32 v7, v7, v39, v131 bitop3:0xf6
    v_and_b32 v7, s58, v7
    v_cmp_ne_u32 vcc, 0, v7
    s_cbranch_vccz L_fpoll_go
    s_mov_b64 exec, vcc
    buffer_load_dwordx4 v[32:35], v6, s[36:39], s62 offen sc1
    s_and_b32 exec_hi, exec_hi, 0xffff
    buffer_load_dwordx4 v[36:39], v6, s[36:39], s63 offen sc1
    s_mov_b64 exec, -1
    s_add_u32 s57, s57, 1
    s_cmp_lt_u32 s57, 200000
    s_cbranch_scc1 L_fpoll
    s_waitcnt vmcnt(0)
L_fpoll_go:
    v_pk_add_f32 v[32:33], v[32:33], v[36:37]
    v_pk_add_f32 v[34:35], v[34:35], v[38:39]
    s_nop 0
    v_permlane32_swap_b32 v32, v33
    v_permlane32_swap_b32 v34, v35
    v_add_f32 v32, v32, v33
    v_add_f32 v34, v34, v35
    s_nop 1
    v_permlane16_swap_b32 v32, v34
    v_add_f32 v32, v32, v34
    s_nop 1
    v_add_f32_dpp v32, v32, v32 row_ror:8 row_mask:0xf bank_mask:0xf
    s_nop 1
    v_add_f32_dpp v32, v32, v32 row_ror:4 row_mask:0xf bank_mask:0xf
    s_nop 1
    v_add_f32_dpp v32, v32, v32 row_ror:2 row_mask:0xf bank_mask:0xf
    s_nop 1
    v_add_f32_dpp v32, v32, v32 row_ror:1 row_mask:0xf bank_mask:0xf
    v_cvt_pk_bf16_f32 v32, v32, v32
    v_and_b32 v32, s59, v32
    v_add_f32 v32, v22, v32
    v_cvt_pk_bf16_f32 v32, v32, v32
    s_mov_b32 exec_lo, s6
    s_mov_b32 exec_hi, s6
    buffer_store_short v32, v132, s[44:47], s4 offen
    s_cmpk_lg_u32 s2, 128
    s_cbranch_scc1 L_noep
    s_mov_b64 exec, 1
    buffer_store_dword v30, v19, s[36:39], 0 offen sc1
L_noep:
L_kdone:
    s_endpgm
L_wt_1:
    buffer_store_dwordx4 v[28:31], v19, s[36:39], s63 offen sc1
    s_branch L_wb_2
L_wt_3:
    buffer_store_dwordx4 v[48:51], v19, s[36:39], s62 offen sc1
    s_branch L_wb_4
L_wt_5:
    buffer_store_dwordx4 v[28:31], v4, s[36:39], s63 offen sc1
    s_branch L_wb_6
L_wt_7:
    buffer_store_dwordx4 v[92:95], v5, s[36:39], s64 offen sc1
    s_branch L_wb_8
L_wt_9:
    buffer_store_dword v30, v19, s[36:39], s5 offen sc1
    s_branch L_wb_10
L_end:
    s_endpgm
.section .rodata,"a"
.p2align 6
.amdhsa_kernel sequential_preLN__sliding_block_cached__glu_gated_swiglu__decode_kernel
  .amdhsa_next_free_vgpr 168
  .amdhsa_next_free_sgpr 100
  .amdhsa_accum_offset 168
  .amdhsa_group_segment_fixed_size 0
  .amdhsa_kernarg_size 96
  .amdhsa_user_sgpr_count 2
  .amdhsa_user_sgpr_kernarg_segment_ptr 1
  .amdhsa_system_sgpr_workgroup_id_x 1
  .amdhsa_float_denorm_mode_32 3
.end_amdhsa_kernel
```
